```python
import torch

def _softmax(x, axis=-1):
    return torch.softmax(x, dim=axis)
def _gelu(x):
    return torch.nn.functional.gelu(x, approximate="tanh")
def _silu(x):
    return torch.nn.functional.silu(x)
def _sigmoid(x):
    return torch.sigmoid(x)
def _layernorm(x, axis=-1, eps=1e-5):
    m = x.mean(dim=axis, keepdim=True)
    v = x.var(dim=axis, keepdim=True, unbiased=False)
    return (x - m) / torch.sqrt(v + eps)
def _scatter_add(tgt, idx, src, axis=0):
    return tgt.clone().index_add_(axis, idx, src)
def _segment_sum(src, seg, n):
    out = torch.zeros((n,) + src.shape[1:], dtype=src.dtype)
    return out.index_add_(0, seg, src)
def _pad(x, pw):
    flat = tuple(v for pair in reversed(pw) for v in pair)
    return torch.nn.functional.pad(x, flat)

kernel_name = 'sequential_preLN__ssm_conv_s4d__dense_activation_silu__prompt'

def setup_inputs():

    _w = (lambda a: (lambda t: t.to(torch.bfloat16) if t.is_floating_point() else t)(torch.as_tensor(a)))
    def _A_setup():
        Bsz, L, D, N = 1, 2048, 448, 256
        return {
            "u": _w((lambda *s: torch.randn(*s, dtype=torch.bfloat16) * 0.05)(Bsz, L, D)),
            "log_A_real": _w((lambda *s: torch.randn(*s, dtype=torch.bfloat16) * 6.4)(D, N) * 0.5),
            "A_imag": _w((lambda *s: torch.randn(*s, dtype=torch.bfloat16) * 0.05)(D, N) * 3.14),
            "C_real": _w((lambda *s: torch.randn(*s, dtype=torch.bfloat16) * 0.05)(D, N) / N ** 0.5),
            "C_imag": _w((lambda *s: torch.randn(*s, dtype=torch.bfloat16) * 0.05)(D, N) / N ** 0.5),
            "log_dt": _w((lambda *s: torch.randn(*s, dtype=torch.bfloat16) * 0.05)(D) * 0.5 - 4.0),
            "D_skip": _w((lambda *s: torch.randn(*s, dtype=torch.bfloat16) * 0.05)(D)),
        }
    _A_in = _A_setup()

    def _B_setup():
        B, S, D, F = 1, 2048, 448, 1792
        return {
            "x": _w((lambda *s: torch.randn(*s, dtype=torch.bfloat16) * 0.05)(B, S, D)),
            "w1": _w((lambda *s: torch.randn(*s, dtype=torch.bfloat16) * 0.8)(D, F) * (D ** -0.5)),
            "w2": _w((lambda *s: torch.randn(*s, dtype=torch.bfloat16) * 0.2)(F, D) * (F ** -0.5)),
        }
    _B_in = _B_setup()

    return {
        "A_u": _A_in["u"],
        "A_log_A_real": _A_in["log_A_real"],
        "A_A_imag": _A_in["A_imag"],
        "A_C_real": _A_in["C_real"],
        "A_C_imag": _A_in["C_imag"],
        "A_log_dt": _A_in["log_dt"],
        "A_D_skip": _A_in["D_skip"],
        "B_x": _B_in["x"],
        "B_w1": _B_in["w1"],
        "B_w2": _B_in["w2"],
    }

def reference(A_u, A_log_A_real, A_A_imag, A_C_real, A_C_imag, A_log_dt, A_D_skip, B_x, B_w1, B_w2):
    def _A_ref(u, log_A_real, A_imag, C_real, C_imag, log_dt, D_skip):
        L = u.shape[1]
        dt = torch.exp(log_dt)
        A = -torch.exp(log_A_real) + 1j * A_imag
        C = (C_real + 1j * C_imag) * dt[:, None]
        pos = (lambda x, dt: x.to(dt))(torch.arange(L), log_dt.dtype)
        P = torch.exp((A * dt[:, None])[:, :, None] * pos[None, None, :])
        K = 2.0 * torch.einsum("dn,dnl->dl", C, P).real
        L2 = 2 * L
        u_t = (lambda x, *d: x.permute(*d))(u, 0, 2, 1)
        Kf = (lambda x, *a, **k: torch.fft.rfft(x.float(), *a, **k))(K, L2)
        Uf = (lambda x, *a, **k: torch.fft.rfft(x.float(), *a, **k))(u_t, L2)
        y = (lambda x, *a, **k: torch.fft.irfft(x, *a, **k).to(torch.bfloat16))(Uf * Kf[None, :, :], L2)[:, :, :L]
        y = (lambda x, *d: x.permute(*d))(y, 0, 2, 1)
        return y + u * D_skip[None, None, :]

    def _B_ref(x, w1, w2):
        h = torch.einsum("bsd,df->bsf", x, w1)
        h = _silu(h)
        out = torch.einsum("bsf,fd->bsd", h, w2)
        return out

    x = A_u
    h = x + _A_ref(_layernorm(x, axis=-1), A_log_A_real, A_A_imag, A_C_real, A_C_imag, A_log_dt, A_D_skip)
    h2 = h + _B_ref(_layernorm(h, axis=-1), B_w1, B_w2)
    return h2
```

```asm
; @launch grid=(256,1,1) block=(512,1,1) lds=163840
.amdgcn_target "amdgcn-amd-amdhsa--gfx950"
.text
.globl sequential_preLN__ssm_conv_s4d__dense_activation_silu__prompt_kernel
.p2align 8
.type sequential_preLN__ssm_conv_s4d__dense_activation_silu__prompt_kernel,@function
sequential_preLN__ssm_conv_s4d__dense_activation_silu__prompt_kernel:
    s_cmp_ge_u32 s2, 256
    s_cbranch_scc1 L_end
    s_load_dwordx16 s[8:23], s[0:1], 0
    s_load_dwordx4 s[24:27], s[0:1], 64
    s_load_dwordx2 s[28:29], s[0:1], 80
    s_load_dwordx2 s[30:31], s[0:1], 96
    v_lshrrev_b32 v2, 6, v0
    v_and_b32 v1, 63, v0
    v_readfirstlane_b32 s3, v2
    s_and_b32 s36, s2, 7
    s_lshr_b32 s37, s2, 3
    s_mul_i32 s38, s36, 28
    s_add_u32 s4, s38, s37
    s_min_u32 s4, s4, 223
    s_mul_i32 s38, s37, 37
    s_lshr_b32 s38, s38, 8
    s_mul_i32 s39, s38, 7
    s_sub_u32 s6, s37, s39
    s_lshl_b32 s36, s36, 2
    s_add_u32 s5, s36, s38
    s_lshr_b32 s34, s3, 2
    s_lshr_b32 s39, s36, 2
    s_min_u32 s40, s3, 6
    v_and_b32 v6, 15, v1
    v_lshrrev_b32 v7, 4, v1
    v_lshl_add_u32 v7, s40, 2, v7
    s_mul_i32 s41, s37, 57344
    s_mul_i32 s42, s39, 112
    s_add_u32 s41, s41, s42
    v_mul_u32_u24 v124, 3584, v6
    v_lshl_add_u32 v124, v7, 2, v124
    v_add_u32 v124, s41, v124
    s_mul_i32 s41, s39, 229376
    s_lshl_b32 s42, s37, 8
    s_add_u32 s41, s41, s42
    s_add_u32 s41, s41, 15728640
    v_lshlrev_b32 v125, 13, v7
    v_lshl_add_u32 v125, v6, 4, v125
    v_add_u32 v125, s41, v125
    s_mul_i32 s41, s39, 7
    s_add_u32 s41, s41, s40
    s_lshl_b32 s41, s41, 5
    s_add_u32 s41, s41, s37
    s_lshl_b32 s41, s41, 6
    s_add_u32 s41, s41, 131072
    v_mov_b32 v126, s41
    s_lshl_b32 s36, s2, 3
    s_add_u32 s35, s36, s3
    s_mul_i32 s36, s35, 896
    v_lshlrev_b32 v2, 4, v1
    v_add_u32 v2, s36, v2
    s_lshl_b32 s55, s4, 10
    v_lshl_add_u32 v5, v0, 1, s55
    s_lshl_b32 s55, s4, 2
    v_mov_b32 v10, 0
    v_mov_b32 v11, 0
    v_mov_b32 v12, 0
    v_mov_b32 v13, 0
    v_mov_b32 v14, 0
    v_mov_b32 v15, 0
    v_mov_b32 v16, 0
    v_mov_b32 v17, 0
    s_waitcnt lgkmcnt(0)
    s_cmp_eq_u32 s3, 7
    s_cbranch_scc1 L_noxt
    global_load_dword v18, v124, s[8:9]
    global_load_dword v19, v124, s[8:9] offset:896
    global_load_dword v20, v124, s[8:9] offset:1792
    global_load_dword v21, v124, s[8:9] offset:2688
L_noxt:
    s_mov_b32 exec_hi, 0x00ffffff
    global_load_dwordx4 v[10:13], v2, s[8:9]
    s_mov_b64 exec, -1
    s_load_dword s7, s[30:31], 0
    s_load_dword s32, s[18:19], s55
    s_load_dword s33, s[20:21], s55
    global_load_short_d16_hi v14, v5, s[10:11]
    global_load_short_d16_hi v15, v5, s[12:13]
    global_load_short_d16_hi v16, v5, s[14:15]
    global_load_short_d16_hi v17, v5, s[16:17]
    s_add_u32 s40, s2, 32
    s_and_b32 s40, s40, 255
    s_cmp_lt_u32 s40, 196
    s_cselect_b32 s56, 1, 0
    s_min_u32 s41, s40, 195
    s_mul_i32 s42, s41, 2341
    s_lshr_b32 s42, s42, 16
    s_mul_i32 s43, s42, 28
    s_sub_u32 s43, s41, s43
    s_lshl_b32 s44, s42, 3
    s_add_u32 s44, s44, s3
    s_lshl_b32 s45, s42, 1
    s_and_b32 s46, s3, 1
    s_add_u32 s45, s45, s46
    s_lshl_b32 s46, s43, 2
    s_lshr_b32 s47, s3, 1
    s_add_u32 s46, s46, s47
    v_lshrrev_b32 v6, 2, v1
    v_and_b32 v7, 3, v1
    v_lshlrev_b32 v44, 4, v7
    s_mul_i32 s47, s43, 57344
    s_lshl_b32 s48, s44, 6
    s_add_u32 s47, s47, s48
    v_mul_u32_u24 v128, 3584, v6
    v_add3_u32 v128, v128, v44, s47
    s_mul_i32 s47, s46, 14336
    s_lshl_b32 s48, s45, 6
    s_add_u32 s47, s47, s48
    v_mul_u32_u24 v129, 896, v6
    v_add3_u32 v129, v129, v44, s47
    s_mul_i32 s47, s44, 28
    s_add_u32 s47, s47, s43
    s_lshl_b32 s47, s47, 10
    s_add_u32 s47, s47, 1048576
    v_lshl_add_u32 v130, v1, 4, s47
    s_lshr_b32 s47, s46, 4
    s_add_u32 s47, s47, 7
    s_sub_u32 s47, s47, s42
    s_sub_u32 s48, s47, 7
    s_cmp_ge_u32 s47, 7
    s_cselect_b32 s47, s48, s47
    s_lshl_b32 s47, s47, 1
    s_and_b32 s48, s46, 1
    s_add_u32 s47, s47, s48
    s_bfe_u32 s48, s46, 0x30001
    s_mul_i32 s48, s48, 14
    s_add_u32 s47, s47, s48
    s_mul_i32 s48, s45, 112
    s_add_u32 s47, s47, s48
    s_lshl_b32 s47, s47, 10
    s_add_u32 s47, s47, 3145728
    v_lshl_add_u32 v131, v1, 4, s47
    s_lshl_b32 s57, s3, 10
    s_add_u32 s57, s57, 154368
    v_and_b32 v6, 3, v6
    v_lshlrev_b32 v6, 6, v6
    v_lshl_add_u32 v6, v7, 3, v6
    v_bfe_u32 v7, v1, 4, 1
    v_lshl_add_u32 v6, v7, 5, v6
    v_add_u32 v6, s57, v6
    v_lshrrev_b32 v7, 5, v1
    v_lshl_add_u32 v132, v7, 9, v6
    v_lshl_add_u32 v133, v7, 8, v6
    s_lshl_b32 s47, s40, 3
    s_add_u32 s47, s47, s3
    s_lshl_b32 s47, s47, 6
    s_add_u32 s47, s47, 393216
    v_mov_b32 v134, s47
    s_mov_b32 m0, s57
    s_cmp_ge_u32 s2, 224
    s_cbranch_scc1 L_spare
    s_mov_b32 s50, 1069066811
    s_mov_b32 s51, 849703008
    s_mov_b32 s52, 1060205080
    s_mul_i32 s36, s34, 3072
    s_add_u32 s36, s36, 112144
    v_and_b32 v52, 15, v1
    s_and_b32 s38, s3, 1
    s_lshl_b32 s38, s38, 4
    v_add_u32 v52, s38, v52
    v_lshrrev_b32 v53, 4, v1
    s_lshl_b32 s38, s3, 1
    s_and_b32 s38, s38, 4
    v_add_u32 v53, s38, v53
    v_lshlrev_b32 v44, 3, v52
    v_lshl_add_u32 v44, v53, 2, v44
    v_mov_b32 v45, 1
    v_mov_b32 v46, 2
    v_cmp_eq_u32 vcc, 2, v53
    v_lshlrev_b32 v47, 2, v52
    v_add_u32 v47, 256, v47
    v_cndmask_b32 v44, v44, v47, vcc
    v_cmp_eq_u32 vcc, 3, v53
    v_lshlrev_b32 v47, 1, v52
    v_add_u32 v47, 384, v47
    v_cndmask_b32 v44, v44, v47, vcc
    v_cmp_le_u32 vcc, 3, v53
    v_mov_b32 v47, 64
    v_add_u32 v48, 512, v52
    v_cndmask_b32 v46, v46, v47, vcc
    v_cmp_eq_u32 vcc, 4, v53
    v_mov_b32 v47, 32
    v_mov_b32 v49, 0
    v_cndmask_b32 v44, v44, v48, vcc
    v_cndmask_b32 v45, v45, v47, vcc
    v_cmp_le_u32 vcc, 5, v53
    v_mov_b32 v47, 700
    v_lshl_add_u32 v48, v53, 5, v52
    v_cndmask_b32 v44, v44, v47, vcc
    v_cndmask_b32 v45, v45, v49, vcc
    v_cndmask_b32 v46, v46, v49, vcc
    s_movk_i32 s38, 160
    v_cmp_eq_u32 vcc, s38, v48
    v_mov_b32 v47, 640
    s_nop 0
    v_cndmask_b32 v44, v44, v47, vcc
    v_lshl_add_u32 v22, v44, 2, s36
    v_lshl_add_u32 v23, v45, 2, v22
    v_lshl_add_u32 v43, v46, 2, v22
    v_lshl_add_u32 v9, v45, 2, v43
    v_and_b32 v52, 255, v0
    v_lshlrev_b32 v52, 3, v52
    v_add_u32 v52, -3, v52
    v_cvt_f32_i32 v53, v52
    v_lshl_add_u32 v52, v52, 2, s36
    s_sub_u32 s37, s36, 68096
    s_add_u32 s38, s36, 512
    v_add_f32 v45, 1.0, v53
    v_cvt_pk_bf16_f32 v46, v53, v45
    v_mad_i32_i16 v32, v46, 4, s37 op_sel:[0,0,0,0]
    s_nop 0
    v_med3_i32 v32, v32, v52, s38
    s_sub_u32 s37, s37, 4
    s_sub_u32 s38, s38, 4
    v_mad_i32_i16 v33, v46, 4, s37 op_sel:[1,0,0,0]
    s_nop 0
    v_med3_i32 v33, v33, v52, s38
    s_sub_u32 s37, s37, 4
    s_sub_u32 s38, s38, 4
    v_add_f32 v48, 2.0, v53
    v_add_f32 v49, 0x40400000, v53
    v_cvt_pk_bf16_f32 v50, v48, v49
    v_mad_i32_i16 v34, v50, 4, s37 op_sel:[0,0,0,0]
    s_nop 0
    v_med3_i32 v34, v34, v52, s38
    s_sub_u32 s37, s37, 4
    s_sub_u32 s38, s38, 4
    v_mad_i32_i16 v35, v50, 4, s37 op_sel:[1,0,0,0]
    s_nop 0
    v_med3_i32 v35, v35, v52, s38
    s_sub_u32 s37, s37, 4
    s_sub_u32 s38, s38, 4
    v_add_f32 v44, 4.0, v53
    v_add_f32 v45, 0x40a00000, v53
    v_cvt_pk_bf16_f32 v46, v44, v45
    v_mad_i32_i16 v36, v46, 4, s37 op_sel:[0,0,0,0]
    s_nop 0
    v_med3_i32 v36, v36, v52, s38
    s_sub_u32 s37, s37, 4
    s_sub_u32 s38, s38, 4
    v_mad_i32_i16 v37, v46, 4, s37 op_sel:[1,0,0,0]
    s_nop 0
    v_med3_i32 v37, v37, v52, s38
    s_sub_u32 s37, s37, 4
    s_sub_u32 s38, s38, 4
    v_add_f32 v48, 0x40c00000, v53
    v_add_f32 v49, 0x40e00000, v53
    v_cvt_pk_bf16_f32 v50, v48, v49
    v_mad_i32_i16 v38, v50, 4, s37 op_sel:[0,0,0,0]
    s_nop 0
    v_med3_i32 v38, v38, v52, s38
    s_sub_u32 s37, s37, 4
    s_sub_u32 s38, s38, 4
    v_mad_i32_i16 v39, v50, 4, s37 op_sel:[1,0,0,0]
    s_nop 0
    v_med3_i32 v39, v39, v52, s38
    s_sub_u32 s37, s37, 4
    s_sub_u32 s38, s38, 4
    v_add_f32 v44, 0x41000000, v53
    v_add_f32 v45, 0x41100000, v53
    v_cvt_pk_bf16_f32 v46, v44, v45
    v_mad_i32_i16 v40, v46, 4, s37 op_sel:[0,0,0,0]
    s_nop 0
    v_med3_i32 v40, v40, v52, s38
    s_sub_u32 s37, s37, 4
    s_sub_u32 s38, s38, 4
    v_mad_i32_i16 v41, v46, 4, s37 op_sel:[1,0,0,0]
    s_nop 0
    v_med3_i32 v41, v41, v52, s38
    s_sub_u32 s37, s37, 4
    s_sub_u32 s38, s38, 4
    v_add_f32 v48, 0x41200000, v53
    v_add_f32 v49, 0x41300000, v53
    v_cvt_pk_bf16_f32 v50, v48, v49
    v_mad_i32_i16 v42, v50, 4, s37 op_sel:[0,0,0,0]
    s_nop 0
    v_med3_i32 v42, v42, v52, s38
    s_sub_u32 s37, s37, 4
    s_sub_u32 s38, s38, 4
    v_lshlrev_b32 v5, 4, v1
    s_lshl_b32 s36, s6, 3
    s_add_u32 s61, s36, s3
    s_mul_i32 s36, s61, 28672
    s_add_u32 s36, s36, 1051648
    s_lshr_b32 s37, s3, 1
    s_add_u32 s38, s37, 0
    s_and_b32 s38, s38, 3
    s_mul_i32 s38, s38, 7168
    s_add_u32 s38, s38, s36
    s_add_u32 s62, s30, s38
    s_addc_u32 s63, s31, 0
    s_add_u32 s38, s37, 1
    s_and_b32 s38, s38, 3
    s_mul_i32 s38, s38, 7168
    s_add_u32 s38, s38, s36
    s_add_u32 s64, s30, s38
    s_addc_u32 s65, s31, 0
    s_add_u32 s38, s37, 2
    s_and_b32 s38, s38, 3
    s_mul_i32 s38, s38, 7168
    s_add_u32 s38, s38, s36
    s_add_u32 s66, s30, s38
    s_addc_u32 s67, s31, 0
    s_add_u32 s38, s37, 3
    s_and_b32 s38, s38, 3
    s_mul_i32 s38, s38, 7168
    s_add_u32 s38, s38, s36
    s_add_u32 s68, s30, s38
    s_addc_u32 s69, s31, 0
    v_and_b32 v44, 3, v1
    v_mul_u32_u24 v44, 4640, v44
    v_bfe_u32 v45, v1, 2, 2
    v_lshl_add_u32 v44, v45, 7, v44
    v_lshrrev_b32 v54, 4, v1
    v_lshl_add_u32 v44, v54, 4, v44
    s_mul_i32 s36, s34, 18688
    v_add_u32 v141, s36, v44
    v_and_b32 v55, 15, v1
    v_lshlrev_b32 v55, 3, v55
    v_and_b32 v45, 1, v1
    v_mul_u32_u24 v45, 4232, v45
    v_lshl_add_u32 v45, v54, 4, v45
    v_sub_u32 v45, v45, v55
    s_mul_i32 s36, s34, 8704
    s_add_u32 s36, s36, 120704
    v_add_u32 v142, s36, v45
    v_lshl_add_u32 v44, v54, 7, v55
    s_lshl_b32 s36, s34, 12
    s_add_u32 s36, s36, 137984
    v_add_u32 v143, s36, v44
    s_lshl_b32 s36, s4, 13
    s_add_u32 s36, s36, 15728640
    v_lshl_add_u32 v135, v0, 4, s36
    v_min_u32 v44, 27, v1
    s_mul_i32 s36, s6, 14336
    s_lshl_b32 s37, s3, 6
    s_add_u32 s36, s36, s37
    s_add_u32 s36, s36, 393216
    v_lshl_add_u32 v140, v44, 9, s36
    s_lshr_b32 s36, s3, 1
    s_and_b32 s36, s36, 1
    s_mul_i32 s36, s36, 8704
    s_and_b32 s37, s3, 1
    s_mul_i32 s37, s37, 4232
    s_add_u32 s36, s36, s37
    s_add_u32 s36, s36, 124680
    v_lshl_add_u32 v6, v1, 3, s36
    v_mov_b32 v44, 0
    v_mov_b32 v45, 0
    s_mul_i32 s37, s34, 3072
    s_add_u32 s37, s37, 112128
    v_mov_b32 v7, s37
    v_lshlrev_b32 v46, 3, v1
    v_add_u32 v46, 118272, v46
    s_mov_b64 exec, 0x7fff
    ds_write_b64 v6, v[44:45]
    ds_write_b64 v7, v[44:45]
    ds_write_b64 v7, v[44:45] offset:8
    ds_write_b64 v46, v[44:45]
    s_mov_b64 exec, -1
    s_waitcnt vmcnt(0)
    s_cmp_eq_u32 s3, 7
    s_cbranch_scc1 L_noxsm
    global_store_dwordx4 v125, v[18:21], s[30:31] sc1
L_noxsm:
    v_lshlrev_b32 v44, 16, v10
    v_and_b32 v45, 0xffff0000, v10
    v_lshlrev_b32 v46, 16, v11
    v_and_b32 v47, 0xffff0000, v11
    v_lshlrev_b32 v48, 16, v12
    v_and_b32 v49, 0xffff0000, v12
    v_lshlrev_b32 v50, 16, v13
    v_and_b32 v51, 0xffff0000, v13
    v_add_f32 v52, v44, v45
    v_mul_f32 v53, v44, v44
    v_fmac_f32 v53, v45, v45
    v_add_f32 v52, v52, v46
    v_fmac_f32 v53, v46, v46
    v_add_f32 v52, v52, v47
    v_fmac_f32 v53, v47, v47
    v_add_f32 v52, v52, v48
    v_fmac_f32 v53, v48, v48
    v_add_f32 v52, v52, v49
    v_fmac_f32 v53, v49, v49
    v_add_f32 v52, v52, v50
    v_fmac_f32 v53, v50, v50
    v_add_f32 v52, v52, v51
    v_fmac_f32 v53, v51, v51
    s_nop 0
    v_add_f32_dpp v52, v52, v52 row_ror:8 row_mask:0xf bank_mask:0xf
    v_add_f32_dpp v53, v53, v53 row_ror:8 row_mask:0xf bank_mask:0xf
    s_nop 0
    v_add_f32_dpp v52, v52, v52 row_ror:4 row_mask:0xf bank_mask:0xf
    v_add_f32_dpp v53, v53, v53 row_ror:4 row_mask:0xf bank_mask:0xf
    s_nop 0
    v_add_f32_dpp v52, v52, v52 row_ror:2 row_mask:0xf bank_mask:0xf
    v_add_f32_dpp v53, v53, v53 row_ror:2 row_mask:0xf bank_mask:0xf
    s_nop 0
    v_add_f32_dpp v52, v52, v52 row_ror:1 row_mask:0xf bank_mask:0xf
    v_add_f32_dpp v53, v53, v53 row_ror:1 row_mask:0xf bank_mask:0xf
    v_mov_b32 v54, v52
    v_mov_b32 v55, v53
    s_nop 0
    v_permlane16_swap_b32 v52, v54
    v_permlane16_swap_b32 v53, v55
    v_add_f32 v52, v52, v54
    v_add_f32 v53, v53, v55
    v_mov_b32 v54, v52
    v_mov_b32 v55, v53
    s_nop 0
    v_permlane32_swap_b32 v52, v54
    v_permlane32_swap_b32 v53, v55
    v_add_f32 v52, v52, v54
    v_add_f32 v53, v53, v55
    v_mul_f32 v52, 0x3b124925, v52
    v_mul_f32 v53, 0x3b124925, v53
    v_fma_f32 v53, -v52, v52, v53
    v_max_f32 v53, 0, v53
    v_cvt_pk_bf16_f32 v54, v52, v53
    v_lshlrev_b32 v52, 16, v54
    v_and_b32 v54, 0xffff0000, v54
    v_add_f32 v54, 0x3727c5ac, v54
    v_cvt_pk_bf16_f32 v54, v54, v54
    v_and_b32 v54, 0xffff0000, v54
    v_sqrt_f32 v54, v54
    s_nop 0
    v_cvt_pk_bf16_f32 v55, v54, v54
    v_and_b32 v55, 0xffff0000, v55
    s_waitcnt lgkmcnt(0)
    s_add_u32 s7, s7, 1
    v_and_b32 v54, 0xffff0000, v55
    v_lshrrev_b32 v52, 16, v52
    v_or_b32 v54, v54, v52
    v_mov_b32 v55, s7
    s_lshl_b32 s36, s35, 3
    s_add_u32 s36, s36, 4096
    v_mov_b32 v56, s36
    s_mov_b64 exec, 1
    global_store_dwordx2 v56, v[54:55], s[30:31] sc1
    s_mov_b64 exec, -1
    v_mov_b32 v127, s7
    global_load_lds_dwordx4 v128, s[24:25]
    s_lshr_b32 s36, s32, 16
    s_and_b32 s37, s32, 0xffff
    s_cmp_lg_u32 s34, 0
    s_cselect_b32 s36, s36, s37
    s_lshl_b32 s36, s36, 16
    v_mov_b32 v60, s36
    s_mul_i32 s37, s34, 55968
    s_and_b32 s38, s3, 3
    s_lshl_b32 s38, s38, 8
    s_add_u32 s37, s37, s38
    s_mov_b32 m0, s37
    v_mul_f32 v62, s50, v60
    v_fma_f32 v63, v60, s50, -v62
    v_fmac_f32 v63, s51, v60
    v_exp_f32 v61, v62
    v_mul_f32 v63, s52, v63
    v_fmac_f32 v61, v61, v63
    v_mul_f32 v62, s50, v14
    v_fma_f32 v63, v14, s50, -v62
    v_fmac_f32 v63, s51, v14
    v_exp_f32 v64, v62
    v_mul_f32 v63, s52, v63
    v_fmac_f32 v64, v64, v63
    v_cvt_pk_bf16_f32 v61, v61, v64
    v_and_b32 v64, 0xffff0000, v61
    v_lshlrev_b32 v61, 16, v61
    v_mul_f32 v44, -v64, v61
    v_mul_f32 v45, v15, v61
    v_mul_f32 v46, v16, v61
    v_mul_f32 v47, v17, v61
    v_add_f32 v46, v46, v46
    v_add_f32 v47, v47, v47
    s_mov_b32 s38, 1042479491
    v_mul_f32 v60, 1.0, v44
    v_mul_f32 v61, 1.0, v45
    v_mul_f32 v60, s50, v60
    v_mul_f32 v61, s38, v61
    v_exp_f32 v60, v60
    v_fract_f32 v61, v61
    v_mul_f32 v64, 0x41000000, v44
    v_mul_f32 v65, 0x41000000, v45
    v_mul_f32 v64, s50, v64
    v_mul_f32 v65, s38, v65
    v_exp_f32 v64, v64
    v_fract_f32 v65, v65
    v_mul_f32 v68, 0x43800000, v44
    v_mul_f32 v69, 0x43800000, v45
    v_mul_f32 v68, s50, v68
    v_mul_f32 v69, s38, v69
    v_exp_f32 v68, v68
    v_fract_f32 v69, v69
    v_cos_f32 v62, v61
    v_sin_f32 v63, v61
    v_cos_f32 v66, v65
    v_sin_f32 v67, v65
    v_cos_f32 v70, v69
    v_sin_f32 v71, v69
    v_mul_f32 v48, v60, v62
    v_mul_f32 v49, v60, v63
    v_mul_f32 v50, v64, v66
    v_mul_f32 v51, v64, v67
    v_mul_f32 v52, v68, v70
    v_mul_f32 v53, v68, v71
    v_pk_mul_f32 v[58:59], v[50:51], v[50:51] op_sel:[0,0] op_sel_hi:[0,1]
    v_pk_fma_f32 v[58:59], v[50:51], v[50:51], v[58:59] op_sel:[1,1,0] op_sel_hi:[1,0,1] neg_lo:[1,0,0]
    v_pk_mul_f32 v[54:55], v[48:49], v[48:49] op_sel:[0,0] op_sel_hi:[0,1]
    v_pk_fma_f32 v[54:55], v[48:49], v[48:49], v[54:55] op_sel:[1,1,0] op_sel_hi:[1,0,1] neg_lo:[1,0,0]
    v_pk_mul_f32 v[56:57], v[54:55], v[54:55] op_sel:[0,0] op_sel_hi:[0,1]
    v_pk_fma_f32 v[56:57], v[54:55], v[54:55], v[56:57] op_sel:[1,1,0] op_sel_hi:[1,0,1] neg_lo:[1,0,0]
    v_mov_b32 v60, 1.0
    v_mov_b32 v61, 0
    v_cvt_pk_bf16_f32 v80, v60, v61
    ds_write_addtid_b32 v80 offset:22176
    v_cvt_pk_bf16_f32 v81, v50, v51
    ds_write_addtid_b32 v81 offset:23232
    v_cvt_pk_bf16_f32 v82, v58, v59
    ds_write_addtid_b32 v82 offset:24288
    v_cvt_pk_bf16_f32 v83, v46, -v47
    ds_write_addtid_b32 v83 offset:0
    v_pk_mul_f32 v[68:69], v[46:47], v[48:49] op_sel:[0,0] op_sel_hi:[0,1]
    v_pk_fma_f32 v[68:69], v[46:47], v[48:49], v[68:69] op_sel:[1,1,0] op_sel_hi:[1,0,1] neg_lo:[1,0,0]
    v_cvt_pk_bf16_f32 v84, v68, -v69
    ds_write_addtid_b32 v84 offset:1056
    v_pk_mul_f32 v[70:71], v[68:69], v[48:49] op_sel:[0,0] op_sel_hi:[0,1]
    v_pk_mul_f32 v[60:61], v[58:59], v[58:59] op_sel:[0,0] op_sel_hi:[0,1]
    v_pk_mul_f32 v[64:65], v[50:51], v[58:59] op_sel:[0,0] op_sel_hi:[0,1]
    v_pk_fma_f32 v[70:71], v[68:69], v[48:49], v[70:71] op_sel:[1,1,0] op_sel_hi:[1,0,1] neg_lo:[1,0,0]
    v_pk_fma_f32 v[60:61], v[58:59], v[58:59], v[60:61] op_sel:[1,1,0] op_sel_hi:[1,0,1] neg_lo:[1,0,0]
    v_pk_fma_f32 v[64:65], v[50:51], v[58:59], v[64:65] op_sel:[1,1,0] op_sel_hi:[1,0,1] neg_lo:[1,0,0]
    v_cvt_pk_bf16_f32 v85, v70, -v71
    v_cvt_pk_bf16_f32 v86, v60, v61
    v_cvt_pk_bf16_f32 v87, v64, v65
    ds_write_addtid_b32 v85 offset:2112
    ds_write_addtid_b32 v86 offset:26400
    ds_write_addtid_b32 v87 offset:25344
    v_pk_mul_f32 v[68:69], v[70:71], v[48:49] op_sel:[0,0] op_sel_hi:[0,1]
    v_pk_mul_f32 v[62:63], v[60:61], v[58:59] op_sel:[0,0] op_sel_hi:[0,1]
    v_pk_mul_f32 v[66:67], v[64:65], v[58:59] op_sel:[0,0] op_sel_hi:[0,1]
    v_pk_fma_f32 v[68:69], v[70:71], v[48:49], v[68:69] op_sel:[1,1,0] op_sel_hi:[1,0,1] neg_lo:[1,0,0]
    v_pk_fma_f32 v[62:63], v[60:61], v[58:59], v[62:63] op_sel:[1,1,0] op_sel_hi:[1,0,1] neg_lo:[1,0,0]
    v_pk_fma_f32 v[66:67], v[64:65], v[58:59], v[66:67] op_sel:[1,1,0] op_sel_hi:[1,0,1] neg_lo:[1,0,0]
    v_cvt_pk_bf16_f32 v80, v68, -v69
    v_cvt_pk_bf16_f32 v81, v62, v63
    v_cvt_pk_bf16_f32 v82, v66, v67
    ds_write_addtid_b32 v80 offset:3168
    ds_write_addtid_b32 v81 offset:28512
    ds_write_addtid_b32 v82 offset:27456
    v_pk_mul_f32 v[70:71], v[68:69], v[48:49] op_sel:[0,0] op_sel_hi:[0,1]
    v_pk_mul_f32 v[64:65], v[66:67], v[58:59] op_sel:[0,0] op_sel_hi:[0,1]
    v_pk_fma_f32 v[70:71], v[68:69], v[48:49], v[70:71] op_sel:[1,1,0] op_sel_hi:[1,0,1] neg_lo:[1,0,0]
    v_pk_fma_f32 v[64:65], v[66:67], v[58:59], v[64:65] op_sel:[1,1,0] op_sel_hi:[1,0,1] neg_lo:[1,0,0]
    v_cvt_pk_bf16_f32 v83, v70, -v71
    v_cvt_pk_bf16_f32 v84, v64, v65
    ds_write_addtid_b32 v83 offset:4224
    ds_write_addtid_b32 v84 offset:29568
    v_pk_mul_f32 v[68:69], v[70:71], v[48:49] op_sel:[0,0] op_sel_hi:[0,1]
    v_pk_mul_f32 v[60:61], v[62:63], v[58:59] op_sel:[0,0] op_sel_hi:[0,1]
    v_pk_fma_f32 v[68:69], v[70:71], v[48:49], v[68:69] op_sel:[1,1,0] op_sel_hi:[1,0,1] neg_lo:[1,0,0]
    v_pk_fma_f32 v[60:61], v[62:63], v[58:59], v[60:61] op_sel:[1,1,0] op_sel_hi:[1,0,1] neg_lo:[1,0,0]
    v_cvt_pk_bf16_f32 v85, v68, -v69
    v_cvt_pk_bf16_f32 v86, v60, v61
    ds_write_addtid_b32 v85 offset:5280
    ds_write_addtid_b32 v86 offset:30624
    v_pk_mul_f32 v[70:71], v[68:69], v[48:49] op_sel:[0,0] op_sel_hi:[0,1]
    v_pk_mul_f32 v[62:63], v[60:61], v[58:59] op_sel:[0,0] op_sel_hi:[0,1]
    v_pk_mul_f32 v[66:67], v[64:65], v[58:59] op_sel:[0,0] op_sel_hi:[0,1]
    v_pk_fma_f32 v[70:71], v[68:69], v[48:49], v[70:71] op_sel:[1,1,0] op_sel_hi:[1,0,1] neg_lo:[1,0,0]
    v_pk_fma_f32 v[62:63], v[60:61], v[58:59], v[62:63] op_sel:[1,1,0] op_sel_hi:[1,0,1] neg_lo:[1,0,0]
    v_pk_fma_f32 v[66:67], v[64:65], v[58:59], v[66:67] op_sel:[1,1,0] op_sel_hi:[1,0,1] neg_lo:[1,0,0]
    v_cvt_pk_bf16_f32 v87, v70, -v71
    v_cvt_pk_bf16_f32 v80, v62, v63
    v_cvt_pk_bf16_f32 v81, v66, v67
    ds_write_addtid_b32 v87 offset:6336
    ds_write_addtid_b32 v80 offset:32736
    ds_write_addtid_b32 v81 offset:31680
    s_waitcnt vmcnt(2)
    s_cmp_eq_u32 s3, 7
    s_cbranch_scc1 L_pubb
    s_mov_b64 exec, 1
    global_store_dword v126, v127, s[30:31] sc1
    s_mov_b64 exec, -1
L_pubb:
    v_pk_mul_f32 v[68:69], v[70:71], v[48:49] op_sel:[0,0] op_sel_hi:[0,1]
    v_pk_mul_f32 v[64:65], v[66:67], v[58:59] op_sel:[0,0] op_sel_hi:[0,1]
    v_pk_fma_f32 v[68:69], v[70:71], v[48:49], v[68:69] op_sel:[1,1,0] op_sel_hi:[1,0,1] neg_lo:[1,0,0]
    v_pk_fma_f32 v[64:65], v[66:67], v[58:59], v[64:65] op_sel:[1,1,0] op_sel_hi:[1,0,1] neg_lo:[1,0,0]
    v_cvt_pk_bf16_f32 v82, v68, -v69
    v_cvt_pk_bf16_f32 v83, v64, v65
    ds_write_addtid_b32 v82 offset:7392
    ds_write_addtid_b32 v83 offset:33792
    v_pk_mul_f32 v[72:73], v[46:47], v[52:53] op_sel:[0,0] op_sel_hi:[0,1]
    v_pk_mul_f32 v[60:61], v[62:63], v[58:59] op_sel:[0,0] op_sel_hi:[0,1]
    v_pk_mul_f32 v[66:67], v[64:65], v[58:59] op_sel:[0,0] op_sel_hi:[0,1]
    v_pk_fma_f32 v[72:73], v[46:47], v[52:53], v[72:73] op_sel:[1,1,0] op_sel_hi:[1,0,1] neg_lo:[1,0,0]
    v_pk_fma_f32 v[60:61], v[62:63], v[58:59], v[60:61] op_sel:[1,1,0] op_sel_hi:[1,0,1] neg_lo:[1,0,0]
    v_pk_fma_f32 v[66:67], v[64:65], v[58:59], v[66:67] op_sel:[1,1,0] op_sel_hi:[1,0,1] neg_lo:[1,0,0]
    v_cvt_pk_bf16_f32 v84, v72, -v73
    v_cvt_pk_bf16_f32 v85, v60, v61
    v_cvt_pk_bf16_f32 v86, v66, v67
    ds_write_addtid_b32 v84 offset:8448
    ds_write_addtid_b32 v85 offset:34848
    ds_write_addtid_b32 v86 offset:35904
    v_pk_mul_f32 v[74:75], v[72:73], v[52:53] op_sel:[0,0] op_sel_hi:[0,1]
    v_pk_mul_f32 v[62:63], v[60:61], v[58:59] op_sel:[0,0] op_sel_hi:[0,1]
    v_pk_fma_f32 v[74:75], v[72:73], v[52:53], v[74:75] op_sel:[1,1,0] op_sel_hi:[1,0,1] neg_lo:[1,0,0]
    v_pk_fma_f32 v[62:63], v[60:61], v[58:59], v[62:63] op_sel:[1,1,0] op_sel_hi:[1,0,1] neg_lo:[1,0,0]
    v_cvt_pk_bf16_f32 v87, v74, -v75
    v_cvt_pk_bf16_f32 v80, v62, v63
    ds_write_addtid_b32 v87 offset:12672
    ds_write_addtid_b32 v80 offset:36960
    v_pk_mul_f32 v[76:77], v[74:75], v[52:53] op_sel:[0,0] op_sel_hi:[0,1]
    v_pk_mul_f32 v[60:61], v[62:63], v[58:59] op_sel:[0,0] op_sel_hi:[0,1]
    v_pk_mul_f32 v[64:65], v[66:67], v[58:59] op_sel:[0,0] op_sel_hi:[0,1]
    v_pk_fma_f32 v[76:77], v[74:75], v[52:53], v[76:77] op_sel:[1,1,0] op_sel_hi:[1,0,1] neg_lo:[1,0,0]
    v_pk_fma_f32 v[60:61], v[62:63], v[58:59], v[60:61] op_sel:[1,1,0] op_sel_hi:[1,0,1] neg_lo:[1,0,0]
    v_pk_fma_f32 v[64:65], v[66:67], v[58:59], v[64:65] op_sel:[1,1,0] op_sel_hi:[1,0,1] neg_lo:[1,0,0]
    v_cvt_pk_bf16_f32 v81, v76, -v77
    v_cvt_pk_bf16_f32 v82, v60, v61
    v_cvt_pk_bf16_f32 v83, v64, v65
    ds_write_addtid_b32 v81 offset:14784
    ds_write_addtid_b32 v82 offset:39072
    ds_write_addtid_b32 v83 offset:38016
    v_pk_mul_f32 v[78:79], v[76:77], v[52:53] op_sel:[0,0] op_sel_hi:[0,1]
    v_pk_mul_f32 v[66:67], v[64:65], v[58:59] op_sel:[0,0] op_sel_hi:[0,1]
    v_pk_fma_f32 v[78:79], v[76:77], v[52:53], v[78:79] op_sel:[1,1,0] op_sel_hi:[1,0,1] neg_lo:[1,0,0]
    v_pk_fma_f32 v[66:67], v[64:65], v[58:59], v[66:67] op_sel:[1,1,0] op_sel_hi:[1,0,1] neg_lo:[1,0,0]
    v_cvt_pk_bf16_f32 v84, v78, -v79
    v_cvt_pk_bf16_f32 v85, v66, v67
    ds_write_addtid_b32 v84 offset:16896
    ds_write_addtid_b32 v85 offset:40128
    v_pk_mul_f32 v[68:69], v[72:73], v[54:55] op_sel:[0,0] op_sel_hi:[0,1]
    v_pk_mul_f32 v[62:63], v[60:61], v[58:59] op_sel:[0,0] op_sel_hi:[0,1]
    v_pk_mul_f32 v[64:65], v[66:67], v[58:59] op_sel:[0,0] op_sel_hi:[0,1]
    v_pk_fma_f32 v[68:69], v[72:73], v[54:55], v[68:69] op_sel:[1,1,0] op_sel_hi:[1,0,1] neg_lo:[1,0,0]
    v_pk_fma_f32 v[62:63], v[60:61], v[58:59], v[62:63] op_sel:[1,1,0] op_sel_hi:[1,0,1] neg_lo:[1,0,0]
    v_pk_fma_f32 v[64:65], v[66:67], v[58:59], v[64:65] op_sel:[1,1,0] op_sel_hi:[1,0,1] neg_lo:[1,0,0]
    v_cvt_pk_bf16_f32 v86, v68, -v69
    v_cvt_pk_bf16_f32 v87, v62, v63
    v_cvt_pk_bf16_f32 v80, v64, v65
    ds_write_addtid_b32 v86 offset:9504
    ds_write_addtid_b32 v87 offset:41184
    ds_write_addtid_b32 v80 offset:42240
    v_pk_mul_f32 v[70:71], v[68:69], v[54:55] op_sel:[0,0] op_sel_hi:[0,1]
    v_pk_mul_f32 v[60:61], v[62:63], v[58:59] op_sel:[0,0] op_sel_hi:[0,1]
    v_pk_fma_f32 v[70:71], v[68:69], v[54:55], v[70:71] op_sel:[1,1,0] op_sel_hi:[1,0,1] neg_lo:[1,0,0]
    v_pk_fma_f32 v[60:61], v[62:63], v[58:59], v[60:61] op_sel:[1,1,0] op_sel_hi:[1,0,1] neg_lo:[1,0,0]
    v_cvt_pk_bf16_f32 v81, v70, -v71
    v_cvt_pk_bf16_f32 v82, v60, v61
    ds_write_addtid_b32 v81 offset:10560
    ds_write_addtid_b32 v82 offset:43296
    v_pk_mul_f32 v[68:69], v[70:71], v[54:55] op_sel:[0,0] op_sel_hi:[0,1]
    v_pk_mul_f32 v[66:67], v[64:65], v[58:59] op_sel:[0,0] op_sel_hi:[0,1]
    v_pk_fma_f32 v[68:69], v[70:71], v[54:55], v[68:69] op_sel:[1,1,0] op_sel_hi:[1,0,1] neg_lo:[1,0,0]
    v_pk_fma_f32 v[66:67], v[64:65], v[58:59], v[66:67] op_sel:[1,1,0] op_sel_hi:[1,0,1] neg_lo:[1,0,0]
    v_cvt_pk_bf16_f32 v83, v68, -v69
    v_cvt_pk_bf16_f32 v84, v66, v67
    ds_write_addtid_b32 v83 offset:11616
    ds_write_addtid_b32 v84 offset:44352
    v_pk_mul_f32 v[68:69], v[74:75], v[56:57] op_sel:[0,0] op_sel_hi:[0,1]
    v_pk_mul_f32 v[62:63], v[60:61], v[58:59] op_sel:[0,0] op_sel_hi:[0,1]
    v_pk_mul_f32 v[64:65], v[66:67], v[58:59] op_sel:[0,0] op_sel_hi:[0,1]
    v_pk_fma_f32 v[68:69], v[74:75], v[56:57], v[68:69] op_sel:[1,1,0] op_sel_hi:[1,0,1] neg_lo:[1,0,0]
    v_pk_fma_f32 v[62:63], v[60:61], v[58:59], v[62:63] op_sel:[1,1,0] op_sel_hi:[1,0,1] neg_lo:[1,0,0]
    v_pk_fma_f32 v[64:65], v[66:67], v[58:59], v[64:65] op_sel:[1,1,0] op_sel_hi:[1,0,1] neg_lo:[1,0,0]
    v_cvt_pk_bf16_f32 v85, v68, -v69
    v_cvt_pk_bf16_f32 v86, v62, v63
    v_cvt_pk_bf16_f32 v87, v64, v65
    ds_write_addtid_b32 v85 offset:13728
    ds_write_addtid_b32 v86 offset:45408
    ds_write_addtid_b32 v87 offset:46464
    v_pk_mul_f32 v[70:71], v[76:77], v[56:57] op_sel:[0,0] op_sel_hi:[0,1]
    v_pk_mul_f32 v[60:61], v[62:63], v[58:59] op_sel:[0,0] op_sel_hi:[0,1]
    v_pk_mul_f32 v[66:67], v[64:65], v[58:59] op_sel:[0,0] op_sel_hi:[0,1]
    v_pk_fma_f32 v[70:71], v[76:77], v[56:57], v[70:71] op_sel:[1,1,0] op_sel_hi:[1,0,1] neg_lo:[1,0,0]
    v_pk_fma_f32 v[60:61], v[62:63], v[58:59], v[60:61] op_sel:[1,1,0] op_sel_hi:[1,0,1] neg_lo:[1,0,0]
    v_pk_fma_f32 v[66:67], v[64:65], v[58:59], v[66:67] op_sel:[1,1,0] op_sel_hi:[1,0,1] neg_lo:[1,0,0]
    v_cvt_pk_bf16_f32 v80, v70, -v71
    v_cvt_pk_bf16_f32 v81, v60, v61
    v_cvt_pk_bf16_f32 v82, v66, v67
    ds_write_addtid_b32 v80 offset:15840
    ds_write_addtid_b32 v81 offset:47520
    ds_write_addtid_b32 v82 offset:48576
    v_pk_mul_f32 v[68:69], v[78:79], v[52:53] op_sel:[0,0] op_sel_hi:[0,1]
    v_pk_fma_f32 v[68:69], v[78:79], v[52:53], v[68:69] op_sel:[1,1,0] op_sel_hi:[1,0,1] neg_lo:[1,0,0]
    v_cvt_pk_bf16_f32 v83, v68, -v69
    ds_write_addtid_b32 v83 offset:17952
    v_pk_mul_f32 v[70:71], v[68:69], v[52:53] op_sel:[0,0] op_sel_hi:[0,1]
    v_pk_mul_f32 v[62:63], v[60:61], v[58:59] op_sel:[0,0] op_sel_hi:[0,1]
    v_pk_mul_f32 v[64:65], v[66:67], v[58:59] op_sel:[0,0] op_sel_hi:[0,1]
    v_pk_fma_f32 v[70:71], v[68:69], v[52:53], v[70:71] op_sel:[1,1,0] op_sel_hi:[1,0,1] neg_lo:[1,0,0]
    v_pk_fma_f32 v[62:63], v[60:61], v[58:59], v[62:63] op_sel:[1,1,0] op_sel_hi:[1,0,1] neg_lo:[1,0,0]
    v_pk_fma_f32 v[64:65], v[66:67], v[58:59], v[64:65] op_sel:[1,1,0] op_sel_hi:[1,0,1] neg_lo:[1,0,0]
    v_cvt_pk_bf16_f32 v84, v70, -v71
    v_cvt_pk_bf16_f32 v85, v62, v63
    v_cvt_pk_bf16_f32 v86, v64, v65
    ds_write_addtid_b32 v84 offset:19008
    ds_write_addtid_b32 v85 offset:49632
    ds_write_addtid_b32 v86 offset:50688
    v_pk_mul_f32 v[68:69], v[70:71], v[52:53] op_sel:[0,0] op_sel_hi:[0,1]
    v_pk_mul_f32 v[60:61], v[62:63], v[58:59] op_sel:[0,0] op_sel_hi:[0,1]
    v_pk_mul_f32 v[66:67], v[64:65], v[58:59] op_sel:[0,0] op_sel_hi:[0,1]
    v_pk_fma_f32 v[68:69], v[70:71], v[52:53], v[68:69] op_sel:[1,1,0] op_sel_hi:[1,0,1] neg_lo:[1,0,0]
    v_pk_fma_f32 v[60:61], v[62:63], v[58:59], v[60:61] op_sel:[1,1,0] op_sel_hi:[1,0,1] neg_lo:[1,0,0]
    v_pk_fma_f32 v[66:67], v[64:65], v[58:59], v[66:67] op_sel:[1,1,0] op_sel_hi:[1,0,1] neg_lo:[1,0,0]
    v_cvt_pk_bf16_f32 v87, v68, -v69
    v_cvt_pk_bf16_f32 v80, v60, v61
    v_cvt_pk_bf16_f32 v81, v66, v67
    ds_write_addtid_b32 v87 offset:20064
    ds_write_addtid_b32 v80 offset:51744
    ds_write_addtid_b32 v81 offset:52800
    v_pk_mul_f32 v[70:71], v[68:69], v[52:53] op_sel:[0,0] op_sel_hi:[0,1]
    v_pk_mul_f32 v[62:63], v[60:61], v[58:59] op_sel:[0,0] op_sel_hi:[0,1]
    v_pk_mul_f32 v[64:65], v[66:67], v[58:59] op_sel:[0,0] op_sel_hi:[0,1]
    v_pk_fma_f32 v[70:71], v[68:69], v[52:53], v[70:71] op_sel:[1,1,0] op_sel_hi:[1,0,1] neg_lo:[1,0,0]
    v_pk_fma_f32 v[62:63], v[60:61], v[58:59], v[62:63] op_sel:[1,1,0] op_sel_hi:[1,0,1] neg_lo:[1,0,0]
    v_pk_fma_f32 v[64:65], v[66:67], v[58:59], v[64:65] op_sel:[1,1,0] op_sel_hi:[1,0,1] neg_lo:[1,0,0]
    v_cvt_pk_bf16_f32 v82, v70, -v71
    v_cvt_pk_bf16_f32 v83, v62, v63
    v_cvt_pk_bf16_f32 v84, v64, v65
    ds_write_addtid_b32 v82 offset:21120
    ds_write_addtid_b32 v83 offset:53856
    ds_write_addtid_b32 v84 offset:54912
    s_mul_i32 s36, s4, 2341
    s_lshr_b32 s36, s36, 16
    s_mul_i32 s37, s36, 28
    s_sub_u32 s37, s4, s37
    s_lshr_b32 s37, s37, 2
    s_mul_i32 s36, s36, 7
    s_add_u32 s36, s36, s37
    s_lshl_b32 s36, s36, 11
    s_add_u32 s36, s36, 131072
    v_and_b32 v6, 31, v1
    v_lshl_add_u32 v6, v6, 6, s36
    s_cmp_eq_u32 s3, 7
    s_cbranch_scc1 L_ky0
    s_waitcnt vmcnt(1)
    s_branch L_ky1
L_ky0:
    s_waitcnt vmcnt(0)
L_ky1:
    ds_read_b64_tr_b16 v[136:137], v132
    ds_read_b64_tr_b16 v[138:139], v132 offset:256
    s_waitcnt lgkmcnt(0)
    s_barrier
    v_lshlrev_b32 v8, 5, v0
    v_add_u32 v8, 4096, v8
    s_mov_b32 s60, 0
    global_load_dwordx4 v[24:27], v8, s[30:31] sc1
    global_load_dwordx4 v[28:31], v8, s[30:31] offset:16 sc1
    global_load_dword v7, v6, s[30:31] sc1
    s_cmp_eq_u32 s56, 0
    s_cbranch_scc1 L_ks1
    global_store_dwordx4 v130, v[136:139], s[30:31] sc1
L_ks1:
    v_and_b32 v2, 15, v1
    v_lshrrev_b32 v3, 4, v1
    v_mul_u32_u24 v2, 1056, v2
    v_lshl_add_u32 v2, v3, 4, v2
    s_mul_i32 s36, s34, 55968
    s_lshl_b32 s37, s3, 3
    s_and_b32 s37, s37, 16
    s_mul_i32 s37, s37, 1056
    s_add_u32 s37, s37, s36
    s_lshl_b32 s38, s3, 4
    s_and_b32 s38, s38, 16
    s_add_u32 s38, s38, 21
    s_mul_i32 s38, s38, 1056
    s_add_u32 s38, s38, s36
    v_add_u32 v3, s38, v2
    v_add_u32 v2, s37, v2
    ds_read_b128 v[92:95], v2 offset:0
    ds_read_b128 v[96:99], v3 offset:0
    ds_read_b128 v[100:103], v2 offset:64
    ds_read_b128 v[104:107], v3 offset:64
    ds_read_b128 v[108:111], v2 offset:128
    ds_read_b128 v[112:115], v3 offset:128
    ds_read_b128 v[116:119], v2 offset:192
    ds_read_b128 v[120:123], v3 offset:192
    s_waitcnt lgkmcnt(6)
    v_mfma_f32_16x16x32_bf16 v[88:91], v[92:95], v[96:99], 0
    ds_read_b128 v[92:95], v2 offset:256
    ds_read_b128 v[96:99], v3 offset:256
    s_waitcnt lgkmcnt(6)
    v_mfma_f32_16x16x32_bf16 v[88:91], v[100:103], v[104:107], v[88:91]
    ds_read_b128 v[100:103], v2 offset:320
    ds_read_b128 v[104:107], v3 offset:320
    s_waitcnt lgkmcnt(6)
    v_mfma_f32_16x16x32_bf16 v[88:91], v[108:111], v[112:115], v[88:91]
    ds_read_b128 v[108:111], v2 offset:384
    ds_read_b128 v[112:115], v3 offset:384
    s_waitcnt lgkmcnt(6)
    v_mfma_f32_16x16x32_bf16 v[88:91], v[116:119], v[120:123], v[88:91]
    ds_read_b128 v[116:119], v2 offset:448
    ds_read_b128 v[120:123], v3 offset:448
    s_waitcnt lgkmcnt(6)
    v_mfma_f32_16x16x32_bf16 v[88:91], v[92:95], v[96:99], v[88:91]
    ds_read_b128 v[92:95], v2 offset:512
    ds_read_b128 v[96:99], v3 offset:512
    s_waitcnt lgkmcnt(6)
    v_mfma_f32_16x16x32_bf16 v[88:91], v[100:103], v[104:107], v[88:91]
    ds_read_b128 v[100:103], v2 offset:576
    ds_read_b128 v[104:107], v3 offset:576
    s_waitcnt lgkmcnt(6)
    v_mfma_f32_16x16x32_bf16 v[88:91], v[108:111], v[112:115], v[88:91]
    ds_read_b128 v[108:111], v2 offset:640
    ds_read_b128 v[112:115], v3 offset:640
    s_waitcnt lgkmcnt(6)
    v_mfma_f32_16x16x32_bf16 v[88:91], v[116:119], v[120:123], v[88:91]
    ds_read_b128 v[116:119], v2 offset:704
    ds_read_b128 v[120:123], v3 offset:704
    s_waitcnt lgkmcnt(6)
    v_mfma_f32_16x16x32_bf16 v[88:91], v[92:95], v[96:99], v[88:91]
    ds_read_b128 v[92:95], v2 offset:768
    ds_read_b128 v[96:99], v3 offset:768
    s_waitcnt lgkmcnt(6)
    v_mfma_f32_16x16x32_bf16 v[88:91], v[100:103], v[104:107], v[88:91]
    ds_read_b128 v[100:103], v2 offset:832
    ds_read_b128 v[104:107], v3 offset:832
    s_waitcnt lgkmcnt(6)
    v_mfma_f32_16x16x32_bf16 v[88:91], v[108:111], v[112:115], v[88:91]
    ds_read_b128 v[108:111], v2 offset:896
    ds_read_b128 v[112:115], v3 offset:896
    s_waitcnt lgkmcnt(6)
    v_mfma_f32_16x16x32_bf16 v[88:91], v[116:119], v[120:123], v[88:91]
    ds_read_b128 v[116:119], v2 offset:960
    ds_read_b128 v[120:123], v3 offset:960
    s_waitcnt lgkmcnt(6)
    v_mfma_f32_16x16x32_bf16 v[88:91], v[92:95], v[96:99], v[88:91]
    s_waitcnt lgkmcnt(4)
    v_mfma_f32_16x16x32_bf16 v[88:91], v[100:103], v[104:107], v[88:91]
    s_waitcnt lgkmcnt(2)
    v_mfma_f32_16x16x32_bf16 v[88:91], v[108:111], v[112:115], v[88:91]
    s_waitcnt lgkmcnt(0)
    v_mfma_f32_16x16x32_bf16 v[88:91], v[116:119], v[120:123], v[88:91]
    s_nop 7
    ds_write_b32 v9, v91
    ds_write_b32 v43, v90
    ds_write_b32 v23, v89
    ds_write_b32 v22, v88
    s_cmp_lg_u32 s56, 1
    s_cbranch_scc1 L_sq0
    s_waitcnt vmcnt(1)
    s_branch L_sq1
L_sq0:
    s_waitcnt vmcnt(0)
L_sq1:
    v_cmp_ne_u32 vcc, s7, v25
    v_cmp_ne_u32 s[36:37], s7, v27
    v_cmp_ne_u32 s[38:39], s7, v29
    v_cmp_ne_u32 s[40:41], s7, v31
    s_or_b64 s[36:37], s[36:37], vcc
    v_cmp_ne_u32 vcc, s7, v7
    s_or_b64 s[38:39], s[38:39], s[40:41]
    s_or_b64 s[36:37], s[36:37], s[38:39]
    s_or_b64 s[36:37], s[36:37], vcc
    s_cselect_b32 s58, 1, 0
    s_cbranch_scc1 L_st1
    global_load_dwordx4 v[18:21], v135, s[30:31] sc1
L_st1:
    s_mov_b32 m0, s57
    s_cmp_lg_u32 s58, 0
    s_cbranch_scc1 L_sr0
    s_waitcnt vmcnt(1)
    s_branch L_sr1
L_sr0:
    s_waitcnt vmcnt(0)
L_sr1:
    s_mov_b64 exec, 1
    global_store_dword v134, v127, s[30:31] sc1
    s_mov_b64 exec, -1
    global_load_lds_dwordx4 v129, s[26:27]
    s_waitcnt lgkmcnt(0)
    s_barrier
    ds_read_b32 v44, v32 offset:0
    ds_read_b32 v45, v33 offset:4
    ds_read_b32 v46, v34 offset:8
    ds_read_b32 v47, v35 offset:12
    ds_read_b32 v48, v36 offset:16
    ds_read_b32 v49, v37 offset:20
    ds_read_b32 v50, v38 offset:24
    ds_read_b32 v51, v39 offset:28
    ds_read_b32 v52, v40 offset:32
    ds_read_b32 v53, v41 offset:36
    ds_read_b32 v54, v42 offset:40
    v_and_b32 v2, 255, v0
    s_mul_i32 s36, s34, 18688
    v_lshl_add_u32 v2, v2, 4, s36
    s_and_b32 s37, s3, 3
    s_cmp_lg_u32 s37, 0
    s_cbranch_scc1 L_nokz
    v_mov_b32 v56, 0
    v_mov_b32 v57, 0
    v_mov_b32 v58, 0
    v_mov_b32 v59, 0
    s_mov_b64 exec, 0xffffff
    ds_write_b128 v2, v[56:59] offset:0
    ds_write_b128 v2, v[56:59] offset:4640
    ds_write_b128 v2, v[56:59] offset:9280
    ds_write_b128 v2, v[56:59] offset:13920
    s_mov_b64 exec, -1
L_nokz:
    s_waitcnt lgkmcnt(0)
    v_cvt_pk_bf16_f32 v56, v44, v45
    v_cvt_pk_bf16_f32 v57, v46, v47
    v_cvt_pk_bf16_f32 v58, v48, v49
    v_cvt_pk_bf16_f32 v59, v50, v51
    ds_write_b128 v2, v[56:59] offset:384
    v_cvt_pk_bf16_f32 v60, v45, v46
    v_cvt_pk_bf16_f32 v61, v47, v48
    v_cvt_pk_bf16_f32 v62, v49, v50
    v_cvt_pk_bf16_f32 v63, v51, v52
    ds_write_b128 v2, v[60:63] offset:5024
    v_cvt_pk_bf16_f32 v64, v46, v47
    v_cvt_pk_bf16_f32 v65, v48, v49
    v_cvt_pk_bf16_f32 v66, v50, v51
    v_cvt_pk_bf16_f32 v67, v52, v53
    ds_write_b128 v2, v[64:67] offset:9664
    v_cvt_pk_bf16_f32 v68, v47, v48
    v_cvt_pk_bf16_f32 v69, v49, v50
    v_cvt_pk_bf16_f32 v70, v51, v52
    v_cvt_pk_bf16_f32 v71, v53, v54
    ds_write_b128 v2, v[68:71] offset:14304
    s_cmp_eq_u32 s58, 0
    s_cbranch_scc1 L_sdone
L_spoll:
    global_load_dwordx4 v[24:27], v8, s[30:31] sc1
    global_load_dwordx4 v[28:31], v8, s[30:31] offset:16 sc1
    global_load_dword v7, v6, s[30:31] sc1
    s_waitcnt vmcnt(0)
    v_cmp_ne_u32 vcc, s7, v25
    v_cmp_ne_u32 s[36:37], s7, v27
    v_cmp_ne_u32 s[38:39], s7, v29
    v_cmp_ne_u32 s[40:41], s7, v31
    s_or_b64 s[36:37], s[36:37], vcc
    v_cmp_ne_u32 vcc, s7, v7
    s_or_b64 s[38:39], s[38:39], s[40:41]
    s_or_b64 s[36:37], s[36:37], s[38:39]
    s_or_b64 s[36:37], s[36:37], vcc
    s_cbranch_scc0 L_sgot
    s_add_u32 s60, s60, 1
    s_cmp_le_u32 s60, 20000
    s_cbranch_scc1 L_spoll
L_sgot:
    global_load_dwordx4 v[18:21], v135, s[30:31] sc1
L_sdone:
    s_cmp_lg_u32 s58, 0
    s_cbranch_scc1 L_pw0
    s_waitcnt vmcnt(2)
    s_branch L_pw1
L_pw0:
    s_waitcnt vmcnt(0)
L_pw1:
    s_lshl_b32 s42, s33, 16
    s_and_b32 s43, s33, 0xffff0000
    v_and_b32 v25, 0xffff0000, v24
    v_lshlrev_b32 v24, 16, v24
    v_rcp_f32 v25, v25
    v_lshlrev_b32 v44, 16, v18
    v_and_b32 v45, 0xffff0000, v18
    v_sub_f32 v44, v44, v24
    v_sub_f32 v45, v45, v24
    v_cvt_pk_bf16_f32 v46, v44, v45
    v_lshlrev_b32 v44, 16, v46
    v_and_b32 v45, 0xffff0000, v46
    v_mul_f32 v60, v44, v25
    v_mul_f32 v64, v45, v25
    v_and_b32 v27, 0xffff0000, v26
    v_lshlrev_b32 v26, 16, v26
    v_rcp_f32 v27, v27
    v_lshlrev_b32 v48, 16, v19
    v_and_b32 v49, 0xffff0000, v19
    v_sub_f32 v48, v48, v26
    v_sub_f32 v49, v49, v26
    v_cvt_pk_bf16_f32 v50, v48, v49
    v_lshlrev_b32 v48, 16, v50
    v_and_b32 v49, 0xffff0000, v50
    v_mul_f32 v61, v48, v27
    v_mul_f32 v65, v49, v27
    v_and_b32 v29, 0xffff0000, v28
    v_lshlrev_b32 v28, 16, v28
    v_rcp_f32 v29, v29
    v_lshlrev_b32 v44, 16, v20
    v_and_b32 v45, 0xffff0000, v20
    v_sub_f32 v44, v44, v28
    v_sub_f32 v45, v45, v28
    v_cvt_pk_bf16_f32 v46, v44, v45
    v_lshlrev_b32 v44, 16, v46
    v_and_b32 v45, 0xffff0000, v46
    v_mul_f32 v62, v44, v29
    v_mul_f32 v66, v45, v29
    v_and_b32 v31, 0xffff0000, v30
    v_lshlrev_b32 v30, 16, v30
    v_rcp_f32 v31, v31
    v_lshlrev_b32 v48, 16, v21
    v_and_b32 v49, 0xffff0000, v21
    v_sub_f32 v48, v48, v30
    v_sub_f32 v49, v49, v30
    v_cvt_pk_bf16_f32 v50, v48, v49
    v_lshlrev_b32 v48, 16, v50
    v_and_b32 v49, 0xffff0000, v50
    v_mul_f32 v63, v48, v31
    v_mul_f32 v67, v49, v31
    v_lshlrev_b32 v6, 3, v0
    v_sub_u32 v7, 124672, v6
    v_add_u32 v6, 137984, v6
    s_mov_b32 s44, 0x05040100
    s_mov_b32 s45, 0x07060302
    v_cvt_pk_bf16_f32 v52, v63, v62
    v_cvt_pk_bf16_f32 v53, v61, v60
    v_perm_b32 v54, v19, v18, s44
    v_perm_b32 v55, v21, v20, s44
    ds_write_b64 v7, v[52:53] offset:0
    ds_write_b64 v7, v[52:53] offset:4232
    ds_write_b64 v6, v[54:55] offset:0
    v_and_b32 v60, 0xffff0000, v53
    v_lshlrev_b32 v61, 16, v53
    v_and_b32 v62, 0xffff0000, v52
    v_lshlrev_b32 v63, 16, v52
    v_mul_f32 v60, s42, v60
    v_mul_f32 v61, s42, v61
    v_mul_f32 v62, s42, v62
    v_mul_f32 v63, s42, v63
    v_cvt_pk_bf16_f32 v56, v60, v61
    v_cvt_pk_bf16_f32 v57, v62, v63
    ds_write_b64 v6, v[56:57] offset:8192
    v_cvt_pk_bf16_f32 v52, v67, v66
    v_cvt_pk_bf16_f32 v53, v65, v64
    v_perm_b32 v54, v19, v18, s45
    v_perm_b32 v55, v21, v20, s45
    ds_write_b64 v7, v[52:53] offset:8704
    ds_write_b64 v7, v[52:53] offset:12936
    ds_write_b64 v6, v[54:55] offset:4096
    v_and_b32 v64, 0xffff0000, v53
    v_lshlrev_b32 v65, 16, v53
    v_and_b32 v66, 0xffff0000, v52
    v_lshlrev_b32 v67, 16, v52
    v_mul_f32 v64, s43, v64
    v_mul_f32 v65, s43, v65
    v_mul_f32 v66, s43, v66
    v_mul_f32 v67, s43, v67
    v_cvt_pk_bf16_f32 v56, v64, v65
    v_cvt_pk_bf16_f32 v57, v66, v67
    ds_write_b64 v6, v[56:57] offset:12288
    s_waitcnt vmcnt(0)
    ds_read_b64_tr_b16 v[136:137], v133
    ds_read_b64_tr_b16 v[138:139], v133 offset:512
    global_load_dword v124, v140, s[30:31] sc1
    s_waitcnt lgkmcnt(0)
    s_barrier
    s_lshl_b32 s36, s34, 15
    s_add_u32 s36, s36, 40960
    v_add_u32 v3, s36, v5
    s_and_b32 s37, s3, 3
    s_lshl_b32 s37, s37, 10
    v_add_u32 v2, s37, v3
    s_lshl_b32 s36, s3, 2
    s_add_u32 s36, s36, 118272
    v_mov_b32 v4, s36
    v_and_b32 v7, -16, v4
    v_mov_b32 v6, 1
    s_setprio 1
    s_and_b32 s36, s3, 3
    s_cmp_eq_u32 s36, 0
    s_cbranch_scc1 L_cv0
    s_cmp_eq_u32 s36, 1
    s_cbranch_scc1 L_cv1
    s_cmp_eq_u32 s36, 2
    s_cbranch_scc1 L_cv2
L_cv3:
    ds_read_b128 v[40:43], v142 offset:3904
    ds_read_b128 v[44:47], v141 offset:3904
    ds_read_b128 v[48:51], v141 offset:3392
    ds_read_b128 v[52:55], v141 offset:2880
    ds_read_b128 v[56:59], v141 offset:2368
    ds_read_b128 v[60:63], v141 offset:1856
    ds_read_b128 v[64:67], v141 offset:1344
    ds_read_b128 v[68:71], v141 offset:832
    ds_read_b128 v[72:75], v141 offset:320
    ds_read_b128 v[76:79], v142 offset:3648
    ds_read_b128 v[80:83], v141 offset:3648
    ds_read_b128 v[84:87], v141 offset:3136
    s_waitcnt lgkmcnt(10)
    v_mfma_f32_16x16x32_bf16 v[36:39], v[44:47], v[40:43], 0
    ds_read_b128 v[88:91], v141 offset:2624
    ds_read_b128 v[92:95], v141 offset:2112
    s_waitcnt lgkmcnt(11)
    v_mfma_f32_16x16x32_bf16 v[32:35], v[48:51], v[40:43], 0
    ds_read_b128 v[96:99], v141 offset:1600
    s_waitcnt lgkmcnt(11)
    v_mfma_f32_16x16x32_bf16 v[28:31], v[52:55], v[40:43], 0
    ds_read_b128 v[100:103], v141 offset:1088
    s_waitcnt lgkmcnt(11)
    v_mfma_f32_16x16x32_bf16 v[12:15], v[56:59], v[40:43], 0
    ds_read_b128 v[104:107], v141 offset:576
    s_waitcnt lgkmcnt(11)
    v_mfma_f32_16x16x32_bf16 v[8:11], v[60:63], v[40:43], 0
    ds_read_b128 v[108:111], v141 offset:64
    s_waitcnt lgkmcnt(11)
    v_mfma_f32_16x16x32_bf16 v[24:27], v[64:67], v[40:43], 0
    ds_read_b128 v[112:115], v142 offset:3392
    s_waitcnt lgkmcnt(11)
    v_mfma_f32_16x16x32_bf16 v[20:23], v[68:71], v[40:43], 0
    ds_read_b128 v[116:119], v142 offset:3136
    s_waitcnt lgkmcnt(11)
    v_mfma_f32_16x16x32_bf16 v[16:19], v[72:75], v[40:43], 0
    ds_read_b128 v[120:123], v142 offset:2880
    s_waitcnt lgkmcnt(10)
    v_mfma_f32_16x16x32_bf16 v[36:39], v[80:83], v[76:79], v[36:39]
    s_waitcnt vmcnt(0)
    v_cmp_ne_u32 vcc, s7, v124
    s_cbranch_vccz L_fp3_done
    s_mov_b32 s60, 0
L_fp3_poll:
    global_load_dword v124, v140, s[30:31] sc1
    s_waitcnt vmcnt(0)
    v_cmp_ne_u32 vcc, s7, v124
    s_cbranch_vccz L_fp3_done
    s_add_u32 s60, s60, 1
    s_cmp_le_u32 s60, 20000
    s_cbranch_scc1 L_fp3_poll
L_fp3_done:
    s_cmp_eq_u32 s56, 0
    s_cbranch_scc1 L_w2s3
    global_store_dwordx4 v131, v[136:139], s[30:31] sc1
L_w2s3:
    global_load_dwordx4 a[0:3], v5, s[62:63] offset:-3072 sc1
    s_waitcnt lgkmcnt(9)
    v_mfma_f32_16x16x32_bf16 v[32:35], v[84:87], v[76:79], v[32:35]
    s_waitcnt lgkmcnt(8)
    v_mfma_f32_16x16x32_bf16 v[28:31], v[88:91], v[76:79], v[28:31]
    s_waitcnt lgkmcnt(7)
    v_mfma_f32_16x16x32_bf16 v[12:15], v[92:95], v[76:79], v[12:15]
    global_load_dwordx4 a[4:7], v5, s[62:63] offset:-2048 sc1
    ds_read_b128 a[72:75], v142 offset:2624
    s_waitcnt lgkmcnt(7)
    v_mfma_f32_16x16x32_bf16 v[8:11], v[96:99], v[76:79], v[8:11]
    s_waitcnt lgkmcnt(6)
    v_mfma_f32_16x16x32_bf16 v[24:27], v[100:103], v[76:79], v[24:27]
    global_load_dwordx4 a[8:11], v5, s[62:63] offset:-1024 sc1
    s_waitcnt lgkmcnt(5)
    v_mfma_f32_16x16x32_bf16 v[20:23], v[104:107], v[76:79], v[20:23]
    s_waitcnt lgkmcnt(4)
    v_mfma_f32_16x16x32_bf16 v[16:19], v[108:111], v[76:79], v[16:19]
    global_load_dwordx4 a[12:15], v5, s[62:63] offset:0 sc1
    s_waitcnt lgkmcnt(3)
    v_mfma_f32_16x16x32_bf16 v[36:39], v[48:51], v[112:115], v[36:39]
    v_mfma_f32_16x16x32_bf16 v[32:35], v[52:55], v[112:115], v[32:35]
    s_nop 3
    ds_write_b128 v2, v[16:19] offset:0
    ds_read_b128 a[76:79], v142 offset:2368
    v_mfma_f32_16x16x32_bf16 v[28:31], v[56:59], v[112:115], v[28:31]
    global_load_dwordx4 a[16:19], v5, s[62:63] offset:1024 sc1
    v_mfma_f32_16x16x32_bf16 v[12:15], v[60:63], v[112:115], v[12:15]
    v_mfma_f32_16x16x32_bf16 v[8:11], v[64:67], v[112:115], v[8:11]
    global_load_dwordx4 a[20:23], v5, s[62:63] offset:2048 sc1
    v_mfma_f32_16x16x32_bf16 v[24:27], v[68:71], v[112:115], v[24:27]
    v_mfma_f32_16x16x32_bf16 v[20:23], v[72:75], v[112:115], v[20:23]
    global_load_dwordx4 a[24:27], v5, s[62:63] offset:3072 sc1
    ds_read_b128 a[80:83], v142 offset:2112
    s_waitcnt lgkmcnt(5)
    v_mfma_f32_16x16x32_bf16 v[36:39], v[84:87], v[116:119], v[36:39]
    v_mfma_f32_16x16x32_bf16 v[32:35], v[88:91], v[116:119], v[32:35]
    v_mfma_f32_16x16x32_bf16 v[28:31], v[92:95], v[116:119], v[28:31]
    global_load_dwordx4 a[28:31], v5, s[64:65] offset:-3072 sc1
    v_mfma_f32_16x16x32_bf16 v[12:15], v[96:99], v[116:119], v[12:15]
    v_mfma_f32_16x16x32_bf16 v[8:11], v[100:103], v[116:119], v[8:11]
    global_load_dwordx4 a[32:35], v5, s[64:65] offset:-2048 sc1
    ds_read_b128 a[84:87], v142 offset:1856
    v_mfma_f32_16x16x32_bf16 v[24:27], v[104:107], v[116:119], v[24:27]
    v_mfma_f32_16x16x32_bf16 v[20:23], v[108:111], v[116:119], v[20:23]
    global_load_dwordx4 a[36:39], v5, s[64:65] offset:-1024 sc1
    s_waitcnt lgkmcnt(5)
    v_mfma_f32_16x16x32_bf16 v[36:39], v[52:55], v[120:123], v[36:39]
    v_mfma_f32_16x16x32_bf16 v[32:35], v[56:59], v[120:123], v[32:35]
    s_nop 3
    ds_write_b128 v2, v[20:23] offset:4096
    ds_read_b64 v[16:17], v143 offset:1536
    ds_read_b64 v[18:19], v143 offset:9728
    ds_read_b64 v[20:21], v143 offset:2048
    ds_read_b64 v[22:23], v143 offset:10240
    ds_read_b128 a[88:91], v142 offset:1600
    v_mfma_f32_16x16x32_bf16 v[28:31], v[60:63], v[120:123], v[28:31]
    global_load_dwordx4 a[40:43], v5, s[64:65] offset:0 sc1
    v_mfma_f32_16x16x32_bf16 v[12:15], v[64:67], v[120:123], v[12:15]
    v_mfma_f32_16x16x32_bf16 v[8:11], v[68:71], v[120:123], v[8:11]
    global_load_dwordx4 a[44:47], v5, s[64:65] offset:1024 sc1
    v_mfma_f32_16x16x32_bf16 v[24:27], v[72:75], v[120:123], v[24:27]
    ds_read_b128 a[92:95], v142 offset:1344
    s_waitcnt lgkmcnt(11)
    v_mfma_f32_16x16x32_bf16 v[36:39], v[88:91], a[72:75], v[36:39]
    global_load_dwordx4 a[48:51], v5, s[64:65] offset:2048 sc1
    v_mfma_f32_16x16x32_bf16 v[32:35], v[92:95], a[72:75], v[32:35]
    v_mfma_f32_16x16x32_bf16 v[28:31], v[96:99], a[72:75], v[28:31]
    ds_read_b128 a[96:99], v142 offset:1088
    v_mfma_f32_16x16x32_bf16 v[12:15], v[100:103], a[72:75], v[12:15]
    global_load_dwordx4 a[52:55], v5, s[64:65] offset:3072 sc1
    v_mfma_f32_16x16x32_bf16 v[8:11], v[104:107], a[72:75], v[8:11]
    v_mfma_f32_16x16x32_bf16 v[24:27], v[108:111], a[72:75], v[24:27]
    global_load_dwordx4 a[56:59], v5, s[66:67] offset:-3072 sc1
    s_waitcnt lgkmcnt(10)
    v_mfma_f32_16x16x32_bf16 v[36:39], v[56:59], a[76:79], v[36:39]
    ds_read_b128 a[100:103], v142 offset:832
    v_mfma_f32_16x16x32_bf16 v[32:35], v[60:63], a[76:79], v[32:35]
    s_nop 2
    ds_write_b128 v2, v[24:27] offset:8192
    global_load_dwordx4 a[60:63], v5, s[66:67] offset:-2048 sc1
    v_mfma_f32_16x16x32_bf16 v[28:31], v[64:67], a[76:79], v[28:31]
    v_mfma_f32_16x16x32_bf16 v[12:15], v[68:71], a[76:79], v[12:15]
    v_mfma_f32_16x16x32_bf16 v[8:11], v[72:75], a[76:79], v[8:11]
    global_load_dwordx4 a[64:67], v5, s[66:67] offset:-1024 sc1
    s_waitcnt lgkmcnt(11)
    v_mfma_f32_16x16x32_bf16 v[36:39], v[92:95], a[80:83], v[36:39]
    ds_read_b128 v[44:47], v142 offset:576
    v_mfma_f32_16x16x32_bf16 v[32:35], v[96:99], a[80:83], v[32:35]
    global_load_dwordx4 a[68:71], v5, s[66:67] offset:0 sc1
    v_mfma_f32_16x16x32_bf16 v[28:31], v[100:103], a[80:83], v[28:31]
    v_mfma_f32_16x16x32_bf16 v[12:15], v[104:107], a[80:83], v[12:15]
    v_mfma_f32_16x16x32_bf16 v[8:11], v[108:111], a[80:83], v[8:11]
    s_waitcnt lgkmcnt(11)
    v_mfma_f32_16x16x32_bf16 v[36:39], v[60:63], a[84:87], v[36:39]
    ds_read_b128 v[40:43], v142 offset:320
    v_mfma_f32_16x16x32_bf16 v[32:35], v[64:67], a[84:87], v[32:35]
    v_mfma_f32_16x16x32_bf16 v[28:31], v[68:71], a[84:87], v[28:31]
    v_mfma_f32_16x16x32_bf16 v[12:15], v[72:75], a[84:87], v[12:15]
    s_waitcnt lgkmcnt(6)
    v_mfma_f32_16x16x32_bf16 v[36:39], v[96:99], a[88:91], v[36:39]
    ds_read_b128 v[80:83], v142 offset:64
    v_mfma_f32_16x16x32_bf16 v[32:35], v[100:103], a[88:91], v[32:35]
    v_mfma_f32_16x16x32_bf16 v[28:31], v[104:107], a[88:91], v[28:31]
    v_mfma_f32_16x16x32_bf16 v[12:15], v[108:111], a[88:91], v[12:15]
    s_waitcnt lgkmcnt(6)
    v_mfma_f32_16x16x32_bf16 v[36:39], v[64:67], a[92:95], v[36:39]
    v_mfma_f32_16x16x32_bf16 v[32:35], v[68:71], a[92:95], v[32:35]
    v_mfma_f32_16x16x32_bf16 v[28:31], v[72:75], a[92:95], v[28:31]
    s_waitcnt lgkmcnt(5)
    v_mfma_f32_16x16x32_bf16 v[36:39], v[100:103], a[96:99], v[36:39]
    v_mfma_f32_16x16x32_bf16 v[32:35], v[104:107], a[96:99], v[32:35]
    v_mfma_f32_16x16x32_bf16 v[28:31], v[108:111], a[96:99], v[28:31]
    s_waitcnt lgkmcnt(4)
    v_mfma_f32_16x16x32_bf16 v[36:39], v[68:71], a[100:103], v[36:39]
    v_mfma_f32_16x16x32_bf16 v[32:35], v[72:75], a[100:103], v[32:35]
    s_nop 4
    ds_write_b128 v2, v[28:31] offset:20480
    s_waitcnt lgkmcnt(3)
    v_mfma_f32_16x16x32_bf16 v[36:39], v[104:107], v[44:47], v[36:39]
    v_mfma_f32_16x16x32_bf16 v[32:35], v[108:111], v[44:47], v[32:35]
    s_waitcnt lgkmcnt(2)
    v_mfma_f32_16x16x32_bf16 v[36:39], v[72:75], v[40:43], v[36:39]
    s_waitcnt lgkmcnt(1)
    v_mfma_f32_16x16x32_bf16 v[36:39], v[108:111], v[80:83], v[36:39]
    s_nop 3
    ds_write_b128 v2, v[32:35] offset:24576
    s_nop 2
    ds_write_b128 v2, v[36:39] offset:28672
    ds_write_b32 v4, v6
    s_setprio 0
    s_movk_i32 s38, 12
    s_movk_i32 s39, 16
    v_add_u32 v125, 12288, v3
    v_add_u32 v126, 16384, v3
    s_branch L_cvdone
L_cv2:
    ds_read_b128 v[40:43], v142 offset:4032
    ds_read_b128 v[44:47], v141 offset:4032
    ds_read_b128 v[48:51], v141 offset:3520
    ds_read_b128 v[52:55], v141 offset:3008
    ds_read_b128 v[56:59], v141 offset:2496
    ds_read_b128 v[60:63], v141 offset:1984
    ds_read_b128 v[64:67], v141 offset:1472
    ds_read_b128 v[68:71], v141 offset:960
    ds_read_b128 v[72:75], v141 offset:448
    ds_read_b128 v[76:79], v142 offset:3776
    ds_read_b128 v[80:83], v141 offset:3776
    ds_read_b128 v[84:87], v141 offset:3264
    s_waitcnt lgkmcnt(10)
    v_mfma_f32_16x16x32_bf16 v[36:39], v[44:47], v[40:43], 0
    ds_read_b128 v[88:91], v141 offset:2752
    ds_read_b128 v[92:95], v141 offset:2240
    s_waitcnt lgkmcnt(11)
    v_mfma_f32_16x16x32_bf16 v[32:35], v[48:51], v[40:43], 0
    ds_read_b128 v[96:99], v141 offset:1728
    s_waitcnt lgkmcnt(11)
    v_mfma_f32_16x16x32_bf16 v[12:15], v[52:55], v[40:43], 0
    ds_read_b128 v[100:103], v141 offset:1216
    s_waitcnt lgkmcnt(11)
    v_mfma_f32_16x16x32_bf16 v[28:31], v[56:59], v[40:43], 0
    ds_read_b128 v[104:107], v141 offset:704
    s_waitcnt lgkmcnt(11)
    v_mfma_f32_16x16x32_bf16 v[24:27], v[60:63], v[40:43], 0
    ds_read_b128 v[108:111], v141 offset:192
    s_waitcnt lgkmcnt(11)
    v_mfma_f32_16x16x32_bf16 v[8:11], v[64:67], v[40:43], 0
    ds_read_b128 v[112:115], v142 offset:3520
    s_waitcnt lgkmcnt(11)
    v_mfma_f32_16x16x32_bf16 v[20:23], v[68:71], v[40:43], 0
    ds_read_b128 v[116:119], v142 offset:3264
    s_waitcnt lgkmcnt(11)
    v_mfma_f32_16x16x32_bf16 v[16:19], v[72:75], v[40:43], 0
    ds_read_b128 v[120:123], v142 offset:3008
    s_waitcnt lgkmcnt(10)
    v_mfma_f32_16x16x32_bf16 v[36:39], v[80:83], v[76:79], v[36:39]
    s_waitcnt vmcnt(0)
    v_cmp_ne_u32 vcc, s7, v124
    s_cbranch_vccz L_fp2_done
    s_mov_b32 s60, 0
L_fp2_poll:
    global_load_dword v124, v140, s[30:31] sc1
    s_waitcnt vmcnt(0)
    v_cmp_ne_u32 vcc, s7, v124
    s_cbranch_vccz L_fp2_done
    s_add_u32 s60, s60, 1
    s_cmp_le_u32 s60, 20000
    s_cbranch_scc1 L_fp2_poll
L_fp2_done:
    s_cmp_eq_u32 s56, 0
    s_cbranch_scc1 L_w2s2
    global_store_dwordx4 v131, v[136:139], s[30:31] sc1
L_w2s2:
    global_load_dwordx4 a[0:3], v5, s[62:63] offset:-3072 sc1
    s_waitcnt lgkmcnt(9)
    v_mfma_f32_16x16x32_bf16 v[32:35], v[84:87], v[76:79], v[32:35]
    s_waitcnt lgkmcnt(8)
    v_mfma_f32_16x16x32_bf16 v[12:15], v[88:91], v[76:79], v[12:15]
    s_waitcnt lgkmcnt(7)
    v_mfma_f32_16x16x32_bf16 v[28:31], v[92:95], v[76:79], v[28:31]
    global_load_dwordx4 a[4:7], v5, s[62:63] offset:-2048 sc1
    ds_read_b128 a[72:75], v142 offset:2752
    s_waitcnt lgkmcnt(7)
    v_mfma_f32_16x16x32_bf16 v[24:27], v[96:99], v[76:79], v[24:27]
    s_waitcnt lgkmcnt(6)
    v_mfma_f32_16x16x32_bf16 v[8:11], v[100:103], v[76:79], v[8:11]
    global_load_dwordx4 a[8:11], v5, s[62:63] offset:-1024 sc1
    s_waitcnt lgkmcnt(5)
    v_mfma_f32_16x16x32_bf16 v[20:23], v[104:107], v[76:79], v[20:23]
    s_waitcnt lgkmcnt(4)
    v_mfma_f32_16x16x32_bf16 v[16:19], v[108:111], v[76:79], v[16:19]
    global_load_dwordx4 a[12:15], v5, s[62:63] offset:0 sc1
    s_waitcnt lgkmcnt(3)
    v_mfma_f32_16x16x32_bf16 v[36:39], v[48:51], v[112:115], v[36:39]
    v_mfma_f32_16x16x32_bf16 v[32:35], v[52:55], v[112:115], v[32:35]
    s_nop 3
    ds_write_b128 v2, v[16:19] offset:0
    ds_read_b128 a[76:79], v142 offset:2496
    v_mfma_f32_16x16x32_bf16 v[12:15], v[56:59], v[112:115], v[12:15]
    global_load_dwordx4 a[16:19], v5, s[62:63] offset:1024 sc1
    v_mfma_f32_16x16x32_bf16 v[28:31], v[60:63], v[112:115], v[28:31]
    v_mfma_f32_16x16x32_bf16 v[24:27], v[64:67], v[112:115], v[24:27]
    global_load_dwordx4 a[20:23], v5, s[62:63] offset:2048 sc1
    v_mfma_f32_16x16x32_bf16 v[8:11], v[68:71], v[112:115], v[8:11]
    v_mfma_f32_16x16x32_bf16 v[20:23], v[72:75], v[112:115], v[20:23]
    global_load_dwordx4 a[24:27], v5, s[62:63] offset:3072 sc1
    ds_read_b128 a[80:83], v142 offset:2240
    s_waitcnt lgkmcnt(5)
    v_mfma_f32_16x16x32_bf16 v[36:39], v[84:87], v[116:119], v[36:39]
    v_mfma_f32_16x16x32_bf16 v[32:35], v[88:91], v[116:119], v[32:35]
    v_mfma_f32_16x16x32_bf16 v[12:15], v[92:95], v[116:119], v[12:15]
    global_load_dwordx4 a[28:31], v5, s[64:65] offset:-3072 sc1
    v_mfma_f32_16x16x32_bf16 v[28:31], v[96:99], v[116:119], v[28:31]
    v_mfma_f32_16x16x32_bf16 v[24:27], v[100:103], v[116:119], v[24:27]
    global_load_dwordx4 a[32:35], v5, s[64:65] offset:-2048 sc1
    ds_read_b128 a[84:87], v142 offset:1984
    v_mfma_f32_16x16x32_bf16 v[8:11], v[104:107], v[116:119], v[8:11]
    v_mfma_f32_16x16x32_bf16 v[20:23], v[108:111], v[116:119], v[20:23]
    global_load_dwordx4 a[36:39], v5, s[64:65] offset:-1024 sc1
    s_waitcnt lgkmcnt(5)
    v_mfma_f32_16x16x32_bf16 v[36:39], v[52:55], v[120:123], v[36:39]
    v_mfma_f32_16x16x32_bf16 v[32:35], v[56:59], v[120:123], v[32:35]
    s_nop 3
    ds_write_b128 v2, v[20:23] offset:4096
    ds_read_b64 v[16:17], v143 offset:1024
    ds_read_b64 v[18:19], v143 offset:9216
    ds_read_b64 v[20:21], v143 offset:2560
    ds_read_b64 v[22:23], v143 offset:10752
    ds_read_b128 a[88:91], v142 offset:1728
    v_mfma_f32_16x16x32_bf16 v[12:15], v[60:63], v[120:123], v[12:15]
    global_load_dwordx4 a[40:43], v5, s[64:65] offset:0 sc1
    v_mfma_f32_16x16x32_bf16 v[28:31], v[64:67], v[120:123], v[28:31]
    v_mfma_f32_16x16x32_bf16 v[24:27], v[68:71], v[120:123], v[24:27]
    global_load_dwordx4 a[44:47], v5, s[64:65] offset:1024 sc1
    v_mfma_f32_16x16x32_bf16 v[8:11], v[72:75], v[120:123], v[8:11]
    ds_read_b128 a[92:95], v142 offset:1472
    s_waitcnt lgkmcnt(11)
    v_mfma_f32_16x16x32_bf16 v[36:39], v[88:91], a[72:75], v[36:39]
    global_load_dwordx4 a[48:51], v5, s[64:65] offset:2048 sc1
    v_mfma_f32_16x16x32_bf16 v[32:35], v[92:95], a[72:75], v[32:35]
    v_mfma_f32_16x16x32_bf16 v[12:15], v[96:99], a[72:75], v[12:15]
    ds_read_b128 a[96:99], v142 offset:1216
    v_mfma_f32_16x16x32_bf16 v[28:31], v[100:103], a[72:75], v[28:31]
    global_load_dwordx4 a[52:55], v5, s[64:65] offset:3072 sc1
    v_mfma_f32_16x16x32_bf16 v[24:27], v[104:107], a[72:75], v[24:27]
    v_mfma_f32_16x16x32_bf16 v[8:11], v[108:111], a[72:75], v[8:11]
    global_load_dwordx4 a[56:59], v5, s[66:67] offset:-3072 sc1
    s_waitcnt lgkmcnt(10)
    v_mfma_f32_16x16x32_bf16 v[36:39], v[56:59], a[76:79], v[36:39]
    ds_read_b128 a[100:103], v142 offset:960
    v_mfma_f32_16x16x32_bf16 v[32:35], v[60:63], a[76:79], v[32:35]
    global_load_dwordx4 a[60:63], v5, s[66:67] offset:-2048 sc1
    ds_read_b128 v[44:47], v142 offset:704
    v_mfma_f32_16x16x32_bf16 v[12:15], v[64:67], a[76:79], v[12:15]
    v_mfma_f32_16x16x32_bf16 v[28:31], v[68:71], a[76:79], v[28:31]
    v_mfma_f32_16x16x32_bf16 v[24:27], v[72:75], a[76:79], v[24:27]
    global_load_dwordx4 a[64:67], v5, s[66:67] offset:-1024 sc1
    s_waitcnt lgkmcnt(11)
    v_mfma_f32_16x16x32_bf16 v[36:39], v[92:95], a[80:83], v[36:39]
    ds_read_b128 v[40:43], v142 offset:448
    v_mfma_f32_16x16x32_bf16 v[32:35], v[96:99], a[80:83], v[32:35]
    global_load_dwordx4 a[68:71], v5, s[66:67] offset:0 sc1
    v_mfma_f32_16x16x32_bf16 v[12:15], v[100:103], a[80:83], v[12:15]
    v_mfma_f32_16x16x32_bf16 v[28:31], v[104:107], a[80:83], v[28:31]
    v_mfma_f32_16x16x32_bf16 v[24:27], v[108:111], a[80:83], v[24:27]
    s_waitcnt lgkmcnt(11)
    v_mfma_f32_16x16x32_bf16 v[36:39], v[60:63], a[84:87], v[36:39]
    ds_read_b128 v[80:83], v142 offset:192
    v_mfma_f32_16x16x32_bf16 v[32:35], v[64:67], a[84:87], v[32:35]
    s_nop 3
    ds_write_b128 v2, v[24:27] offset:12288
    v_mfma_f32_16x16x32_bf16 v[12:15], v[68:71], a[84:87], v[12:15]
    v_mfma_f32_16x16x32_bf16 v[28:31], v[72:75], a[84:87], v[28:31]
    s_waitcnt lgkmcnt(7)
    v_mfma_f32_16x16x32_bf16 v[36:39], v[96:99], a[88:91], v[36:39]
    v_mfma_f32_16x16x32_bf16 v[32:35], v[100:103], a[88:91], v[32:35]
    v_mfma_f32_16x16x32_bf16 v[12:15], v[104:107], a[88:91], v[12:15]
    v_mfma_f32_16x16x32_bf16 v[28:31], v[108:111], a[88:91], v[28:31]
    s_waitcnt lgkmcnt(6)
    v_mfma_f32_16x16x32_bf16 v[36:39], v[64:67], a[92:95], v[36:39]
    v_mfma_f32_16x16x32_bf16 v[32:35], v[68:71], a[92:95], v[32:35]
    s_nop 4
    ds_write_b128 v2, v[28:31] offset:16384
    v_mfma_f32_16x16x32_bf16 v[12:15], v[72:75], a[92:95], v[12:15]
    s_waitcnt lgkmcnt(6)
    v_mfma_f32_16x16x32_bf16 v[36:39], v[100:103], a[96:99], v[36:39]
    v_mfma_f32_16x16x32_bf16 v[32:35], v[104:107], a[96:99], v[32:35]
    v_mfma_f32_16x16x32_bf16 v[12:15], v[108:111], a[96:99], v[12:15]
    s_waitcnt lgkmcnt(5)
    v_mfma_f32_16x16x32_bf16 v[36:39], v[68:71], a[100:103], v[36:39]
    v_mfma_f32_16x16x32_bf16 v[32:35], v[72:75], a[100:103], v[32:35]
    s_waitcnt lgkmcnt(4)
    v_mfma_f32_16x16x32_bf16 v[36:39], v[104:107], v[44:47], v[36:39]
    v_mfma_f32_16x16x32_bf16 v[32:35], v[108:111], v[44:47], v[32:35]
    s_waitcnt lgkmcnt(3)
    v_mfma_f32_16x16x32_bf16 v[36:39], v[72:75], v[40:43], v[36:39]
    s_waitcnt lgkmcnt(2)
    v_mfma_f32_16x16x32_bf16 v[36:39], v[108:111], v[80:83], v[36:39]
    s_nop 3
    ds_write_b128 v2, v[32:35] offset:24576
    s_nop 2
    ds_write_b128 v2, v[36:39] offset:28672
    ds_write_b32 v4, v6
    s_setprio 0
    s_movk_i32 s38, 8
    s_movk_i32 s39, 20
    v_add_u32 v125, 8192, v3
    v_add_u32 v126, 20480, v3
    s_branch L_cvdone
L_cv1:
    ds_read_b128 v[40:43], v142 offset:3840
    ds_read_b128 v[44:47], v141 offset:3840
    ds_read_b128 v[48:51], v141 offset:3328
    ds_read_b128 v[52:55], v141 offset:2816
    ds_read_b128 v[56:59], v141 offset:2304
    ds_read_b128 v[60:63], v141 offset:1792
    ds_read_b128 v[64:67], v141 offset:1280
    ds_read_b128 v[68:71], v141 offset:768
    ds_read_b128 v[72:75], v141 offset:256
    ds_read_b128 v[76:79], v142 offset:3584
    ds_read_b128 v[80:83], v141 offset:3584
    ds_read_b128 v[84:87], v141 offset:3072
    s_waitcnt lgkmcnt(10)
    v_mfma_f32_16x16x32_bf16 v[36:39], v[44:47], v[40:43], 0
    ds_read_b128 v[88:91], v141 offset:2560
    ds_read_b128 v[92:95], v141 offset:2048
    s_waitcnt lgkmcnt(11)
    v_mfma_f32_16x16x32_bf16 v[12:15], v[48:51], v[40:43], 0
    ds_read_b128 v[96:99], v141 offset:1536
    s_waitcnt lgkmcnt(11)
    v_mfma_f32_16x16x32_bf16 v[32:35], v[52:55], v[40:43], 0
    ds_read_b128 v[100:103], v141 offset:1024
    s_waitcnt lgkmcnt(11)
    v_mfma_f32_16x16x32_bf16 v[28:31], v[56:59], v[40:43], 0
    ds_read_b128 v[104:107], v141 offset:512
    s_waitcnt lgkmcnt(11)
    v_mfma_f32_16x16x32_bf16 v[24:27], v[60:63], v[40:43], 0
    ds_read_b128 v[108:111], v141 offset:0
    s_waitcnt lgkmcnt(11)
    v_mfma_f32_16x16x32_bf16 v[20:23], v[64:67], v[40:43], 0
    ds_read_b128 v[112:115], v142 offset:3328
    s_waitcnt lgkmcnt(11)
    v_mfma_f32_16x16x32_bf16 v[8:11], v[68:71], v[40:43], 0
    ds_read_b128 v[116:119], v142 offset:3072
    s_waitcnt lgkmcnt(11)
    v_mfma_f32_16x16x32_bf16 v[16:19], v[72:75], v[40:43], 0
    ds_read_b128 v[120:123], v142 offset:2816
    s_waitcnt lgkmcnt(10)
    v_mfma_f32_16x16x32_bf16 v[36:39], v[80:83], v[76:79], v[36:39]
    s_waitcnt vmcnt(0)
    v_cmp_ne_u32 vcc, s7, v124
    s_cbranch_vccz L_fp1_done
    s_mov_b32 s60, 0
L_fp1_poll:
    global_load_dword v124, v140, s[30:31] sc1
    s_waitcnt vmcnt(0)
    v_cmp_ne_u32 vcc, s7, v124
    s_cbranch_vccz L_fp1_done
    s_add_u32 s60, s60, 1
    s_cmp_le_u32 s60, 20000
    s_cbranch_scc1 L_fp1_poll
L_fp1_done:
    s_cmp_eq_u32 s56, 0
    s_cbranch_scc1 L_w2s1
    global_store_dwordx4 v131, v[136:139], s[30:31] sc1
L_w2s1:
    global_load_dwordx4 a[0:3], v5, s[62:63] offset:-3072 sc1
    s_waitcnt lgkmcnt(9)
    v_mfma_f32_16x16x32_bf16 v[12:15], v[84:87], v[76:79], v[12:15]
    s_waitcnt lgkmcnt(8)
    v_mfma_f32_16x16x32_bf16 v[32:35], v[88:91], v[76:79], v[32:35]
    s_waitcnt lgkmcnt(7)
    v_mfma_f32_16x16x32_bf16 v[28:31], v[92:95], v[76:79], v[28:31]
    global_load_dwordx4 a[4:7], v5, s[62:63] offset:-2048 sc1
    ds_read_b128 a[72:75], v142 offset:2560
    s_waitcnt lgkmcnt(7)
    v_mfma_f32_16x16x32_bf16 v[24:27], v[96:99], v[76:79], v[24:27]
    s_waitcnt lgkmcnt(6)
    v_mfma_f32_16x16x32_bf16 v[20:23], v[100:103], v[76:79], v[20:23]
    global_load_dwordx4 a[8:11], v5, s[62:63] offset:-1024 sc1
    s_waitcnt lgkmcnt(5)
    v_mfma_f32_16x16x32_bf16 v[8:11], v[104:107], v[76:79], v[8:11]
    s_waitcnt lgkmcnt(4)
    v_mfma_f32_16x16x32_bf16 v[16:19], v[108:111], v[76:79], v[16:19]
    global_load_dwordx4 a[12:15], v5, s[62:63] offset:0 sc1
    s_waitcnt lgkmcnt(3)
    v_mfma_f32_16x16x32_bf16 v[36:39], v[48:51], v[112:115], v[36:39]
    v_mfma_f32_16x16x32_bf16 v[12:15], v[52:55], v[112:115], v[12:15]
    s_nop 3
    ds_write_b128 v2, v[16:19] offset:0
    ds_read_b128 a[76:79], v142 offset:2304
    v_mfma_f32_16x16x32_bf16 v[32:35], v[56:59], v[112:115], v[32:35]
    global_load_dwordx4 a[16:19], v5, s[62:63] offset:1024 sc1
    v_mfma_f32_16x16x32_bf16 v[28:31], v[60:63], v[112:115], v[28:31]
    v_mfma_f32_16x16x32_bf16 v[24:27], v[64:67], v[112:115], v[24:27]
    global_load_dwordx4 a[20:23], v5, s[62:63] offset:2048 sc1
    v_mfma_f32_16x16x32_bf16 v[20:23], v[68:71], v[112:115], v[20:23]
    v_mfma_f32_16x16x32_bf16 v[8:11], v[72:75], v[112:115], v[8:11]
    global_load_dwordx4 a[24:27], v5, s[62:63] offset:3072 sc1
    ds_read_b128 a[80:83], v142 offset:2048
    s_waitcnt lgkmcnt(5)
    v_mfma_f32_16x16x32_bf16 v[36:39], v[84:87], v[116:119], v[36:39]
    v_mfma_f32_16x16x32_bf16 v[12:15], v[88:91], v[116:119], v[12:15]
    v_mfma_f32_16x16x32_bf16 v[32:35], v[92:95], v[116:119], v[32:35]
    global_load_dwordx4 a[28:31], v5, s[64:65] offset:-3072 sc1
    v_mfma_f32_16x16x32_bf16 v[28:31], v[96:99], v[116:119], v[28:31]
    v_mfma_f32_16x16x32_bf16 v[24:27], v[100:103], v[116:119], v[24:27]
    global_load_dwordx4 a[32:35], v5, s[64:65] offset:-2048 sc1
    ds_read_b128 a[84:87], v142 offset:1792
    v_mfma_f32_16x16x32_bf16 v[20:23], v[104:107], v[116:119], v[20:23]
    v_mfma_f32_16x16x32_bf16 v[8:11], v[108:111], v[116:119], v[8:11]
    global_load_dwordx4 a[36:39], v5, s[64:65] offset:-1024 sc1
    s_waitcnt lgkmcnt(5)
    v_mfma_f32_16x16x32_bf16 v[36:39], v[52:55], v[120:123], v[36:39]
    v_mfma_f32_16x16x32_bf16 v[12:15], v[56:59], v[120:123], v[12:15]
    ds_read_b128 a[88:91], v142 offset:1536
    v_mfma_f32_16x16x32_bf16 v[32:35], v[60:63], v[120:123], v[32:35]
    global_load_dwordx4 a[40:43], v5, s[64:65] offset:0 sc1
    v_mfma_f32_16x16x32_bf16 v[28:31], v[64:67], v[120:123], v[28:31]
    v_mfma_f32_16x16x32_bf16 v[24:27], v[68:71], v[120:123], v[24:27]
    global_load_dwordx4 a[44:47], v5, s[64:65] offset:1024 sc1
    v_mfma_f32_16x16x32_bf16 v[20:23], v[72:75], v[120:123], v[20:23]
    ds_read_b128 a[92:95], v142 offset:1280
    s_waitcnt lgkmcnt(6)
    v_mfma_f32_16x16x32_bf16 v[36:39], v[88:91], a[72:75], v[36:39]
    global_load_dwordx4 a[48:51], v5, s[64:65] offset:2048 sc1
    v_mfma_f32_16x16x32_bf16 v[12:15], v[92:95], a[72:75], v[12:15]
    v_mfma_f32_16x16x32_bf16 v[32:35], v[96:99], a[72:75], v[32:35]
    ds_read_b128 a[96:99], v142 offset:1024
    v_mfma_f32_16x16x32_bf16 v[28:31], v[100:103], a[72:75], v[28:31]
    global_load_dwordx4 a[52:55], v5, s[64:65] offset:3072 sc1
    v_mfma_f32_16x16x32_bf16 v[24:27], v[104:107], a[72:75], v[24:27]
    v_mfma_f32_16x16x32_bf16 v[20:23], v[108:111], a[72:75], v[20:23]
    global_load_dwordx4 a[56:59], v5, s[66:67] offset:-3072 sc1
    ds_read_b128 a[100:103], v142 offset:768
    s_waitcnt lgkmcnt(6)
    v_mfma_f32_16x16x32_bf16 v[36:39], v[56:59], a[76:79], v[36:39]
    v_mfma_f32_16x16x32_bf16 v[12:15], v[60:63], a[76:79], v[12:15]
    s_nop 2
    ds_write_b128 v2, v[20:23] offset:8192
    ds_read_b64 v[16:17], v143 offset:512
    ds_read_b64 v[18:19], v143 offset:8704
    ds_read_b64 v[20:21], v143 offset:3072
    ds_read_b64 v[22:23], v143 offset:11264
    global_load_dwordx4 a[60:63], v5, s[66:67] offset:-2048 sc1
    ds_read_b128 v[44:47], v142 offset:512
    v_mfma_f32_16x16x32_bf16 v[32:35], v[64:67], a[76:79], v[32:35]
    v_mfma_f32_16x16x32_bf16 v[28:31], v[68:71], a[76:79], v[28:31]
    v_mfma_f32_16x16x32_bf16 v[24:27], v[72:75], a[76:79], v[24:27]
    global_load_dwordx4 a[64:67], v5, s[66:67] offset:-1024 sc1
    s_waitcnt lgkmcnt(11)
    v_mfma_f32_16x16x32_bf16 v[36:39], v[92:95], a[80:83], v[36:39]
    ds_read_b128 v[40:43], v142 offset:256
    v_mfma_f32_16x16x32_bf16 v[12:15], v[96:99], a[80:83], v[12:15]
    global_load_dwordx4 a[68:71], v5, s[66:67] offset:0 sc1
    v_mfma_f32_16x16x32_bf16 v[32:35], v[100:103], a[80:83], v[32:35]
    v_mfma_f32_16x16x32_bf16 v[28:31], v[104:107], a[80:83], v[28:31]
    v_mfma_f32_16x16x32_bf16 v[24:27], v[108:111], a[80:83], v[24:27]
    s_waitcnt lgkmcnt(11)
    v_mfma_f32_16x16x32_bf16 v[36:39], v[60:63], a[84:87], v[36:39]
    ds_read_b128 v[80:83], v142 offset:0
    v_mfma_f32_16x16x32_bf16 v[12:15], v[64:67], a[84:87], v[12:15]
    s_nop 3
    ds_write_b128 v2, v[24:27] offset:12288
    v_mfma_f32_16x16x32_bf16 v[32:35], v[68:71], a[84:87], v[32:35]
    v_mfma_f32_16x16x32_bf16 v[28:31], v[72:75], a[84:87], v[28:31]
    s_waitcnt lgkmcnt(12)
    v_mfma_f32_16x16x32_bf16 v[36:39], v[96:99], a[88:91], v[36:39]
    v_mfma_f32_16x16x32_bf16 v[12:15], v[100:103], a[88:91], v[12:15]
    v_mfma_f32_16x16x32_bf16 v[32:35], v[104:107], a[88:91], v[32:35]
    v_mfma_f32_16x16x32_bf16 v[28:31], v[108:111], a[88:91], v[28:31]
    s_waitcnt lgkmcnt(11)
    v_mfma_f32_16x16x32_bf16 v[36:39], v[64:67], a[92:95], v[36:39]
    v_mfma_f32_16x16x32_bf16 v[12:15], v[68:71], a[92:95], v[12:15]
    s_nop 4
    ds_write_b128 v2, v[28:31] offset:16384
    v_mfma_f32_16x16x32_bf16 v[32:35], v[72:75], a[92:95], v[32:35]
    s_waitcnt lgkmcnt(11)
    v_mfma_f32_16x16x32_bf16 v[36:39], v[100:103], a[96:99], v[36:39]
    v_mfma_f32_16x16x32_bf16 v[12:15], v[104:107], a[96:99], v[12:15]
    v_mfma_f32_16x16x32_bf16 v[32:35], v[108:111], a[96:99], v[32:35]
    s_waitcnt lgkmcnt(10)
    v_mfma_f32_16x16x32_bf16 v[36:39], v[68:71], a[100:103], v[36:39]
    v_mfma_f32_16x16x32_bf16 v[12:15], v[72:75], a[100:103], v[12:15]
    s_nop 4
    ds_write_b128 v2, v[32:35] offset:20480
    s_waitcnt lgkmcnt(5)
    v_mfma_f32_16x16x32_bf16 v[36:39], v[104:107], v[44:47], v[36:39]
    v_mfma_f32_16x16x32_bf16 v[12:15], v[108:111], v[44:47], v[12:15]
    s_waitcnt lgkmcnt(4)
    v_mfma_f32_16x16x32_bf16 v[36:39], v[72:75], v[40:43], v[36:39]
    s_waitcnt lgkmcnt(3)
    v_mfma_f32_16x16x32_bf16 v[36:39], v[108:111], v[80:83], v[36:39]
    s_nop 7
    ds_write_b128 v2, v[36:39] offset:28672
    ds_write_b32 v4, v6
    s_setprio 0
    s_movk_i32 s38, 4
    s_movk_i32 s39, 24
    v_add_u32 v125, 4096, v3
    v_add_u32 v126, 24576, v3
    s_branch L_cvdone
L_cv0:
    ds_read_b128 v[40:43], v142 offset:3968
    ds_read_b128 v[44:47], v141 offset:3968
    ds_read_b128 v[48:51], v141 offset:3456
    ds_read_b128 v[52:55], v141 offset:2944
    ds_read_b128 v[56:59], v141 offset:2432
    ds_read_b128 v[60:63], v141 offset:1920
    ds_read_b128 v[64:67], v141 offset:1408
    ds_read_b128 v[68:71], v141 offset:896
    ds_read_b128 v[72:75], v141 offset:384
    ds_read_b128 v[76:79], v142 offset:3712
    ds_read_b128 v[80:83], v141 offset:3712
    ds_read_b128 v[84:87], v141 offset:3200
    s_waitcnt lgkmcnt(10)
    v_mfma_f32_16x16x32_bf16 v[12:15], v[44:47], v[40:43], 0
    ds_read_b128 v[88:91], v141 offset:2688
    ds_read_b128 v[92:95], v141 offset:2176
    s_waitcnt lgkmcnt(11)
    v_mfma_f32_16x16x32_bf16 v[36:39], v[48:51], v[40:43], 0
    ds_read_b128 v[96:99], v141 offset:1664
    s_waitcnt lgkmcnt(11)
    v_mfma_f32_16x16x32_bf16 v[32:35], v[52:55], v[40:43], 0
    ds_read_b128 v[100:103], v141 offset:1152
    s_waitcnt lgkmcnt(11)
    v_mfma_f32_16x16x32_bf16 v[28:31], v[56:59], v[40:43], 0
    ds_read_b128 v[104:107], v141 offset:640
    s_waitcnt lgkmcnt(11)
    v_mfma_f32_16x16x32_bf16 v[24:27], v[60:63], v[40:43], 0
    ds_read_b128 v[108:111], v141 offset:128
    s_waitcnt lgkmcnt(11)
    v_mfma_f32_16x16x32_bf16 v[20:23], v[64:67], v[40:43], 0
    ds_read_b128 v[112:115], v142 offset:3456
    s_waitcnt lgkmcnt(11)
    v_mfma_f32_16x16x32_bf16 v[16:19], v[68:71], v[40:43], 0
    ds_read_b128 v[116:119], v142 offset:3200
    s_waitcnt lgkmcnt(11)
    v_mfma_f32_16x16x32_bf16 v[8:11], v[72:75], v[40:43], 0
    ds_read_b128 v[120:123], v142 offset:2944
    s_waitcnt lgkmcnt(10)
    v_mfma_f32_16x16x32_bf16 v[12:15], v[80:83], v[76:79], v[12:15]
    s_waitcnt vmcnt(0)
    v_cmp_ne_u32 vcc, s7, v124
    s_cbranch_vccz L_fp0_done
    s_mov_b32 s60, 0
L_fp0_poll:
    global_load_dword v124, v140, s[30:31] sc1
    s_waitcnt vmcnt(0)
    v_cmp_ne_u32 vcc, s7, v124
    s_cbranch_vccz L_fp0_done
    s_add_u32 s60, s60, 1
    s_cmp_le_u32 s60, 20000
    s_cbranch_scc1 L_fp0_poll
L_fp0_done:
    s_cmp_eq_u32 s56, 0
    s_cbranch_scc1 L_w2s0
    global_store_dwordx4 v131, v[136:139], s[30:31] sc1
L_w2s0:
    global_load_dwordx4 a[0:3], v5, s[62:63] offset:-3072 sc1
    s_waitcnt lgkmcnt(9)
    v_mfma_f32_16x16x32_bf16 v[36:39], v[84:87], v[76:79], v[36:39]
    s_waitcnt lgkmcnt(8)
    v_mfma_f32_16x16x32_bf16 v[32:35], v[88:91], v[76:79], v[32:35]
    s_waitcnt lgkmcnt(7)
    v_mfma_f32_16x16x32_bf16 v[28:31], v[92:95], v[76:79], v[28:31]
    global_load_dwordx4 a[4:7], v5, s[62:63] offset:-2048 sc1
    ds_read_b128 a[72:75], v142 offset:2688
    s_waitcnt lgkmcnt(7)
    v_mfma_f32_16x16x32_bf16 v[24:27], v[96:99], v[76:79], v[24:27]
    s_waitcnt lgkmcnt(6)
    v_mfma_f32_16x16x32_bf16 v[20:23], v[100:103], v[76:79], v[20:23]
    global_load_dwordx4 a[8:11], v5, s[62:63] offset:-1024 sc1
    s_waitcnt lgkmcnt(5)
    v_mfma_f32_16x16x32_bf16 v[16:19], v[104:107], v[76:79], v[16:19]
    s_waitcnt lgkmcnt(4)
    v_mfma_f32_16x16x32_bf16 v[8:11], v[108:111], v[76:79], v[8:11]
    global_load_dwordx4 a[12:15], v5, s[62:63] offset:0 sc1
    s_waitcnt lgkmcnt(3)
    v_mfma_f32_16x16x32_bf16 v[12:15], v[48:51], v[112:115], v[12:15]
    v_mfma_f32_16x16x32_bf16 v[36:39], v[52:55], v[112:115], v[36:39]
    ds_read_b128 a[76:79], v142 offset:2432
    v_mfma_f32_16x16x32_bf16 v[32:35], v[56:59], v[112:115], v[32:35]
    global_load_dwordx4 a[16:19], v5, s[62:63] offset:1024 sc1
    v_mfma_f32_16x16x32_bf16 v[28:31], v[60:63], v[112:115], v[28:31]
    v_mfma_f32_16x16x32_bf16 v[24:27], v[64:67], v[112:115], v[24:27]
    global_load_dwordx4 a[20:23], v5, s[62:63] offset:2048 sc1
    v_mfma_f32_16x16x32_bf16 v[20:23], v[68:71], v[112:115], v[20:23]
    v_mfma_f32_16x16x32_bf16 v[16:19], v[72:75], v[112:115], v[16:19]
    global_load_dwordx4 a[24:27], v5, s[62:63] offset:3072 sc1
    ds_read_b128 a[80:83], v142 offset:2176
    s_waitcnt lgkmcnt(4)
    v_mfma_f32_16x16x32_bf16 v[12:15], v[84:87], v[116:119], v[12:15]
    v_mfma_f32_16x16x32_bf16 v[36:39], v[88:91], v[116:119], v[36:39]
    v_mfma_f32_16x16x32_bf16 v[32:35], v[92:95], v[116:119], v[32:35]
    global_load_dwordx4 a[28:31], v5, s[64:65] offset:-3072 sc1
    v_mfma_f32_16x16x32_bf16 v[28:31], v[96:99], v[116:119], v[28:31]
    v_mfma_f32_16x16x32_bf16 v[24:27], v[100:103], v[116:119], v[24:27]
    global_load_dwordx4 a[32:35], v5, s[64:65] offset:-2048 sc1
    ds_read_b128 a[84:87], v142 offset:1920
    v_mfma_f32_16x16x32_bf16 v[20:23], v[104:107], v[116:119], v[20:23]
    v_mfma_f32_16x16x32_bf16 v[16:19], v[108:111], v[116:119], v[16:19]
    global_load_dwordx4 a[36:39], v5, s[64:65] offset:-1024 sc1
    s_waitcnt lgkmcnt(4)
    v_mfma_f32_16x16x32_bf16 v[12:15], v[52:55], v[120:123], v[12:15]
    v_mfma_f32_16x16x32_bf16 v[36:39], v[56:59], v[120:123], v[36:39]
    s_nop 3
    ds_write_b128 v2, v[16:19] offset:4096
    ds_read_b128 a[88:91], v142 offset:1664
    v_mfma_f32_16x16x32_bf16 v[32:35], v[60:63], v[120:123], v[32:35]
    global_load_dwordx4 a[40:43], v5, s[64:65] offset:0 sc1
    v_mfma_f32_16x16x32_bf16 v[28:31], v[64:67], v[120:123], v[28:31]
    v_mfma_f32_16x16x32_bf16 v[24:27], v[68:71], v[120:123], v[24:27]
    global_load_dwordx4 a[44:47], v5, s[64:65] offset:1024 sc1
    v_mfma_f32_16x16x32_bf16 v[20:23], v[72:75], v[120:123], v[20:23]
    ds_read_b128 a[92:95], v142 offset:1408
    s_waitcnt lgkmcnt(6)
    v_mfma_f32_16x16x32_bf16 v[12:15], v[88:91], a[72:75], v[12:15]
    global_load_dwordx4 a[48:51], v5, s[64:65] offset:2048 sc1
    v_mfma_f32_16x16x32_bf16 v[36:39], v[92:95], a[72:75], v[36:39]
    v_mfma_f32_16x16x32_bf16 v[32:35], v[96:99], a[72:75], v[32:35]
    ds_read_b128 a[96:99], v142 offset:1152
    v_mfma_f32_16x16x32_bf16 v[28:31], v[100:103], a[72:75], v[28:31]
    global_load_dwordx4 a[52:55], v5, s[64:65] offset:3072 sc1
    v_mfma_f32_16x16x32_bf16 v[24:27], v[104:107], a[72:75], v[24:27]
    v_mfma_f32_16x16x32_bf16 v[20:23], v[108:111], a[72:75], v[20:23]
    global_load_dwordx4 a[56:59], v5, s[66:67] offset:-3072 sc1
    ds_read_b128 a[100:103], v142 offset:896
    s_waitcnt lgkmcnt(7)
    v_mfma_f32_16x16x32_bf16 v[12:15], v[56:59], a[76:79], v[12:15]
    v_mfma_f32_16x16x32_bf16 v[36:39], v[60:63], a[76:79], v[36:39]
    s_nop 2
    ds_write_b128 v2, v[20:23] offset:8192
    ds_read_b64 v[16:17], v143 offset:0
    ds_read_b64 v[18:19], v143 offset:8192
    ds_read_b64 v[20:21], v143 offset:3584
    ds_read_b64 v[22:23], v143 offset:11776
    global_load_dwordx4 a[60:63], v5, s[66:67] offset:-2048 sc1
    v_mfma_f32_16x16x32_bf16 v[32:35], v[64:67], a[76:79], v[32:35]
    v_mfma_f32_16x16x32_bf16 v[28:31], v[68:71], a[76:79], v[28:31]
    v_mfma_f32_16x16x32_bf16 v[24:27], v[72:75], a[76:79], v[24:27]
    global_load_dwordx4 a[64:67], v5, s[66:67] offset:-1024 sc1
    s_waitcnt lgkmcnt(11)
    v_mfma_f32_16x16x32_bf16 v[12:15], v[92:95], a[80:83], v[12:15]
    ds_read_b128 v[44:47], v142 offset:640
    v_mfma_f32_16x16x32_bf16 v[36:39], v[96:99], a[80:83], v[36:39]
    global_load_dwordx4 a[68:71], v5, s[66:67] offset:0 sc1
    v_mfma_f32_16x16x32_bf16 v[32:35], v[100:103], a[80:83], v[32:35]
    v_mfma_f32_16x16x32_bf16 v[28:31], v[104:107], a[80:83], v[28:31]
    v_mfma_f32_16x16x32_bf16 v[24:27], v[108:111], a[80:83], v[24:27]
    s_waitcnt lgkmcnt(11)
    v_mfma_f32_16x16x32_bf16 v[12:15], v[60:63], a[84:87], v[12:15]
    ds_read_b128 v[40:43], v142 offset:384
    v_mfma_f32_16x16x32_bf16 v[36:39], v[64:67], a[84:87], v[36:39]
    s_nop 3
    ds_write_b128 v2, v[24:27] offset:12288
    v_mfma_f32_16x16x32_bf16 v[32:35], v[68:71], a[84:87], v[32:35]
    v_mfma_f32_16x16x32_bf16 v[28:31], v[72:75], a[84:87], v[28:31]
    s_waitcnt lgkmcnt(11)
    v_mfma_f32_16x16x32_bf16 v[12:15], v[96:99], a[88:91], v[12:15]
    ds_read_b128 v[80:83], v142 offset:128
    v_mfma_f32_16x16x32_bf16 v[36:39], v[100:103], a[88:91], v[36:39]
    v_mfma_f32_16x16x32_bf16 v[32:35], v[104:107], a[88:91], v[32:35]
    v_mfma_f32_16x16x32_bf16 v[28:31], v[108:111], a[88:91], v[28:31]
    s_waitcnt lgkmcnt(11)
    v_mfma_f32_16x16x32_bf16 v[12:15], v[64:67], a[92:95], v[12:15]
    v_mfma_f32_16x16x32_bf16 v[36:39], v[68:71], a[92:95], v[36:39]
    s_nop 4
    ds_write_b128 v2, v[28:31] offset:16384
    v_mfma_f32_16x16x32_bf16 v[32:35], v[72:75], a[92:95], v[32:35]
    s_waitcnt lgkmcnt(11)
    v_mfma_f32_16x16x32_bf16 v[12:15], v[100:103], a[96:99], v[12:15]
    v_mfma_f32_16x16x32_bf16 v[36:39], v[104:107], a[96:99], v[36:39]
    v_mfma_f32_16x16x32_bf16 v[32:35], v[108:111], a[96:99], v[32:35]
    s_waitcnt lgkmcnt(10)
    v_mfma_f32_16x16x32_bf16 v[12:15], v[68:71], a[100:103], v[12:15]
    v_mfma_f32_16x16x32_bf16 v[36:39], v[72:75], a[100:103], v[36:39]
    s_nop 4
    ds_write_b128 v2, v[32:35] offset:20480
    s_waitcnt lgkmcnt(5)
    v_mfma_f32_16x16x32_bf16 v[12:15], v[104:107], v[44:47], v[12:15]
    v_mfma_f32_16x16x32_bf16 v[36:39], v[108:111], v[44:47], v[36:39]
    s_waitcnt lgkmcnt(4)
    v_mfma_f32_16x16x32_bf16 v[12:15], v[72:75], v[40:43], v[12:15]
    s_waitcnt lgkmcnt(2)
    v_mfma_f32_16x16x32_bf16 v[12:15], v[108:111], v[80:83], v[12:15]
    s_nop 3
    ds_write_b128 v2, v[36:39] offset:24576
    ds_write_b32 v4, v6
    s_setprio 0
    s_movk_i32 s38, 0
    s_movk_i32 s39, 28
    v_add_u32 v125, 0, v3
    v_add_u32 v126, 28672, v3
L_cvdone:
    s_and_b32 s40, s3, 3
    s_xor_b32 s41, s40, 1
    s_xor_b32 s42, s40, 2
    s_xor_b32 s43, s40, 3
    s_mov_b32 s60, 0
    s_lshl_b32 s41, s41, 10
    v_add_u32 v48, s41, v125
    v_add_u32 v52, s41, v126
    s_lshl_b32 s42, s42, 10
    v_add_u32 v49, s42, v125
    v_add_u32 v53, s42, v126
    s_lshl_b32 s43, s43, 10
    v_add_u32 v50, s43, v125
    v_add_u32 v54, s43, v126
L_xw:
    ds_read_b128 v[24:27], v7
    s_waitcnt lgkmcnt(0)
    v_and_b32 v24, v24, v25
    v_and_b32 v26, v26, v27
    v_and_b32 v24, v24, v26
    v_cmp_ne_u32 vcc, 1, v24
    s_cbranch_vccz L_xd
    s_add_u32 s60, s60, 1
    s_cmp_le_u32 s60, 20000
    s_cbranch_scc1 L_xw
L_xd:
    ds_read_b128 v[24:27], v48
    ds_read_b128 v[28:31], v52
    ds_read_b128 v[32:35], v49
    ds_read_b128 v[36:39], v53
    ds_read_b128 v[40:43], v50
    ds_read_b128 v[44:47], v54
    s_waitcnt lgkmcnt(4)
    v_add_f32 v8, v8, v24
    v_add_f32 v9, v9, v25
    v_add_f32 v10, v10, v26
    v_add_f32 v11, v11, v27
    v_add_f32 v12, v12, v28
    v_add_f32 v13, v13, v29
    v_add_f32 v14, v14, v30
    v_add_f32 v15, v15, v31
    s_waitcnt lgkmcnt(2)
    v_add_f32 v8, v8, v32
    v_add_f32 v9, v9, v33
    v_add_f32 v10, v10, v34
    v_add_f32 v11, v11, v35
    v_add_f32 v12, v12, v36
    v_add_f32 v13, v13, v37
    v_add_f32 v14, v14, v38
    v_add_f32 v15, v15, v39
    s_waitcnt lgkmcnt(0)
    v_add_f32 v8, v8, v40
    v_add_f32 v9, v9, v41
    v_add_f32 v10, v10, v42
    v_add_f32 v11, v11, v43
    v_add_f32 v12, v12, v44
    v_add_f32 v13, v13, v45
    v_add_f32 v14, v14, v46
    v_add_f32 v15, v15, v47
    v_cvt_pk_bf16_f32 v24, v8, v9
    v_cvt_pk_bf16_f32 v25, v10, v11
    v_lshlrev_b32 v26, 16, v24
    v_and_b32 v27, 0xffff0000, v24
    v_lshlrev_b32 v30, 16, v18
    v_and_b32 v31, 0xffff0000, v18
    v_lshlrev_b32 v28, 16, v25
    v_and_b32 v29, 0xffff0000, v25
    v_lshlrev_b32 v32, 16, v19
    v_and_b32 v33, 0xffff0000, v19
    v_add_f32 v26, v26, v30
    v_add_f32 v27, v27, v31
    v_add_f32 v28, v28, v32
    v_add_f32 v29, v29, v33
    v_cvt_pk_bf16_f32 v24, v26, v27
    v_cvt_pk_bf16_f32 v25, v28, v29
    v_lshlrev_b32 v26, 16, v24
    v_and_b32 v27, 0xffff0000, v24
    v_lshlrev_b32 v30, 16, v16
    v_and_b32 v31, 0xffff0000, v16
    v_lshlrev_b32 v28, 16, v25
    v_and_b32 v29, 0xffff0000, v25
    v_lshlrev_b32 v32, 16, v17
    v_and_b32 v33, 0xffff0000, v17
    v_add_f32 v26, v26, v30
    v_add_f32 v27, v27, v31
    v_add_f32 v28, v28, v32
    v_add_f32 v29, v29, v33
    v_cvt_pk_bf16_f32 v24, v26, v27
    v_cvt_pk_bf16_f32 v25, v28, v29
    v_cvt_pk_bf16_f32 v40, v12, v13
    v_cvt_pk_bf16_f32 v41, v14, v15
    v_lshlrev_b32 v42, 16, v40
    v_and_b32 v43, 0xffff0000, v40
    v_lshlrev_b32 v46, 16, v22
    v_and_b32 v47, 0xffff0000, v22
    v_lshlrev_b32 v44, 16, v41
    v_and_b32 v45, 0xffff0000, v41
    v_lshlrev_b32 v48, 16, v23
    v_and_b32 v49, 0xffff0000, v23
    v_add_f32 v42, v42, v46
    v_add_f32 v43, v43, v47
    v_add_f32 v44, v44, v48
    v_add_f32 v45, v45, v49
    v_cvt_pk_bf16_f32 v40, v42, v43
    v_cvt_pk_bf16_f32 v41, v44, v45
    v_lshlrev_b32 v42, 16, v40
    v_and_b32 v43, 0xffff0000, v40
    v_lshlrev_b32 v46, 16, v20
    v_and_b32 v47, 0xffff0000, v20
    v_lshlrev_b32 v44, 16, v41
    v_and_b32 v45, 0xffff0000, v41
    v_lshlrev_b32 v48, 16, v21
    v_and_b32 v49, 0xffff0000, v21
    v_add_f32 v42, v42, v46
    v_add_f32 v43, v43, v47
    v_add_f32 v44, v44, v48
    v_add_f32 v45, v45, v49
    v_cvt_pk_bf16_f32 v40, v42, v43
    v_cvt_pk_bf16_f32 v41, v44, v45
    s_mov_b32 s70, 0xaaaaaaaa
    s_mov_b32 s71, 0xaaaaaaaa
    v_mov_b32 v2, s38
    v_mov_b32 v3, s39
    v_cndmask_b32 v56, v40, v24, s[70:71]
    v_cndmask_b32 v57, v41, v25, s[70:71]
    v_cndmask_b32 v2, v2, v3, s[70:71]
    v_lshrrev_b32 v3, 4, v1
    v_add_u32 v2, v2, v3
    v_mov_b32_dpp v58, v56 quad_perm:[1,0,3,2] row_mask:0xf bank_mask:0xf
    v_mov_b32_dpp v59, v57 quad_perm:[1,0,3,2] row_mask:0xf bank_mask:0xf
    v_mul_u32_u24 v2, 57344, v2
    v_bfe_u32 v3, v1, 1, 3
    s_and_b32 s36, s4, 1
    s_lshl_b32 s36, s36, 2
    v_xor_b32 v3, s36, v3
    v_lshl_add_u32 v2, v3, 4, v2
    s_lshl_b32 s36, s4, 1
    s_add_u32 s36, s36, s34
    s_lshl_b32 s36, s36, 7
    s_add_u32 s36, s36, 5242880
    v_add_u32 v2, s36, v2
    v_cndmask_b32 v60, v24, v58, s[70:71]
    v_cndmask_b32 v61, v25, v59, s[70:71]
    v_cndmask_b32 v62, v58, v40, s[70:71]
    v_cndmask_b32 v63, v59, v41, s[70:71]
    global_store_dwordx4 v2, v[60:63], s[30:31] sc1
    s_mul_i32 s36, s4, 16
    s_add_u32 s36, s36, 262144
    v_mul_u32_u24 v2, 4096, v1
    v_add_u32 v2, s36, v2
    v_mov_b32 v3, s7
    v_mov_b32 v32, 0x3f803f80
    v_mov_b32 v33, 0x3f803f80
    v_mov_b32 v34, 0x3f803f80
    v_mov_b32 v35, 0x3f803f80
    s_cmp_eq_u32 s34, 0
    s_cbranch_scc0 L_wm1
    s_waitcnt vmcnt(0)
    s_branch L_wm2
L_wm1:
    s_waitcnt vmcnt(0)
L_wm2:
    s_barrier
    s_cmp_lg_u32 s3, 0
    s_cbranch_scc1 L_b2nf
    s_mov_b64 exec, 255
    global_store_dword v2, v3, s[30:31] sc1
    s_mov_b64 exec, -1
L_b2nf:
    s_cmp_eq_u32 s34, 0
    s_cbranch_scc0 L_wm3
    v_mfma_f32_32x32x16_bf16 v[16:31], a[0:3], v[32:35], 0
    v_mfma_f32_32x32x16_bf16 v[16:31], a[4:7], v[32:35], v[16:31]
    global_load_dwordx4 a[72:75], v5, s[66:67] offset:1024 sc1
    v_mfma_f32_32x32x16_bf16 v[16:31], a[8:11], v[32:35], v[16:31]
    v_mfma_f32_32x32x16_bf16 v[16:31], a[12:15], v[32:35], v[16:31]
    global_load_dwordx4 a[76:79], v5, s[66:67] offset:2048 sc1
    v_mfma_f32_32x32x16_bf16 v[16:31], a[16:19], v[32:35], v[16:31]
    v_mfma_f32_32x32x16_bf16 v[16:31], a[20:23], v[32:35], v[16:31]
    global_load_dwordx4 a[80:83], v5, s[66:67] offset:3072 sc1
    v_mfma_f32_32x32x16_bf16 v[16:31], a[24:27], v[32:35], v[16:31]
    v_mfma_f32_32x32x16_bf16 v[16:31], a[28:31], v[32:35], v[16:31]
    global_load_dwordx4 a[84:87], v5, s[68:69] offset:-3072 sc1
    v_mfma_f32_32x32x16_bf16 v[16:31], a[32:35], v[32:35], v[16:31]
    global_load_dwordx4 a[88:91], v5, s[68:69] offset:-2048 sc1
    v_mfma_f32_32x32x16_bf16 v[16:31], a[36:39], v[32:35], v[16:31]
    v_mfma_f32_32x32x16_bf16 v[16:31], a[40:43], v[32:35], v[16:31]
    global_load_dwordx4 a[92:95], v5, s[68:69] offset:-1024 sc1
    v_mfma_f32_32x32x16_bf16 v[16:31], a[44:47], v[32:35], v[16:31]
    v_mfma_f32_32x32x16_bf16 v[16:31], a[48:51], v[32:35], v[16:31]
    global_load_dwordx4 a[96:99], v5, s[68:69] offset:0 sc1
    v_mfma_f32_32x32x16_bf16 v[16:31], a[52:55], v[32:35], v[16:31]
    v_mfma_f32_32x32x16_bf16 v[16:31], a[56:59], v[32:35], v[16:31]
    global_load_dwordx4 a[100:103], v5, s[68:69] offset:1024 sc1
    v_mfma_f32_32x32x16_bf16 v[16:31], a[60:63], v[32:35], v[16:31]
    v_mfma_f32_32x32x16_bf16 v[16:31], a[64:67], v[32:35], v[16:31]
    global_load_dwordx4 a[104:107], v5, s[68:69] offset:2048 sc1
    v_mfma_f32_32x32x16_bf16 v[16:31], a[68:71], v[32:35], v[16:31]
    global_load_dwordx4 a[108:111], v5, s[68:69] offset:3072 sc1
    s_branch L_wm4
L_wm3:
    s_nop 9
    v_mfma_f32_32x32x16_bf16 v[16:31], a[0:3], v[32:35], 0
    v_mfma_f32_32x32x16_bf16 v[16:31], a[4:7], v[32:35], v[16:31]
    global_load_dwordx4 a[72:75], v5, s[66:67] offset:1024 sc1
    v_mfma_f32_32x32x16_bf16 v[16:31], a[8:11], v[32:35], v[16:31]
    v_mfma_f32_32x32x16_bf16 v[16:31], a[12:15], v[32:35], v[16:31]
    global_load_dwordx4 a[76:79], v5, s[66:67] offset:2048 sc1
    v_mfma_f32_32x32x16_bf16 v[16:31], a[16:19], v[32:35], v[16:31]
    v_mfma_f32_32x32x16_bf16 v[16:31], a[20:23], v[32:35], v[16:31]
    global_load_dwordx4 a[80:83], v5, s[66:67] offset:3072 sc1
    v_mfma_f32_32x32x16_bf16 v[16:31], a[24:27], v[32:35], v[16:31]
    v_mfma_f32_32x32x16_bf16 v[16:31], a[28:31], v[32:35], v[16:31]
    global_load_dwordx4 a[84:87], v5, s[68:69] offset:-3072 sc1
    v_mfma_f32_32x32x16_bf16 v[16:31], a[32:35], v[32:35], v[16:31]
    global_load_dwordx4 a[88:91], v5, s[68:69] offset:-2048 sc1
    v_mfma_f32_32x32x16_bf16 v[16:31], a[36:39], v[32:35], v[16:31]
    v_mfma_f32_32x32x16_bf16 v[16:31], a[40:43], v[32:35], v[16:31]
    global_load_dwordx4 a[92:95], v5, s[68:69] offset:-1024 sc1
    v_mfma_f32_32x32x16_bf16 v[16:31], a[44:47], v[32:35], v[16:31]
    v_mfma_f32_32x32x16_bf16 v[16:31], a[48:51], v[32:35], v[16:31]
    global_load_dwordx4 a[96:99], v5, s[68:69] offset:0 sc1
    v_mfma_f32_32x32x16_bf16 v[16:31], a[52:55], v[32:35], v[16:31]
    v_mfma_f32_32x32x16_bf16 v[16:31], a[56:59], v[32:35], v[16:31]
    global_load_dwordx4 a[100:103], v5, s[68:69] offset:1024 sc1
    v_mfma_f32_32x32x16_bf16 v[16:31], a[60:63], v[32:35], v[16:31]
    v_mfma_f32_32x32x16_bf16 v[16:31], a[64:67], v[32:35], v[16:31]
    global_load_dwordx4 a[104:107], v5, s[68:69] offset:2048 sc1
    v_mfma_f32_32x32x16_bf16 v[16:31], a[68:71], v[32:35], v[16:31]
    global_load_dwordx4 a[108:111], v5, s[68:69] offset:3072 sc1
L_wm4:
    s_mul_i32 s36, s5, 57344
    s_mul_i32 s37, s3, 7168
    s_add_u32 s36, s36, s37
    s_add_u32 s36, s36, 5242880
    s_add_u32 s62, s30, s36
    s_addc_u32 s63, s31, 0
    s_add_u32 s64, s62, 4096
    s_addc_u32 s65, s63, 0
    s_mov_b32 m0, s37
    s_cmp_lg_u32 s3, 0
    s_cbranch_scc1 L_b2w
    s_and_b32 s36, s2, 7
    s_mul_i32 s36, s36, 4096
    s_add_u32 s36, s36, 262144
    v_add_u32 v36, 0, v1
    v_mul_u32_u24 v36, 16, v36
    v_add_u32 v36, s36, v36
    v_add_u32 v37, 64, v1
    v_mul_u32_u24 v37, 16, v37
    v_add_u32 v37, s36, v37
    v_add_u32 v38, 128, v1
    v_mul_u32_u24 v38, 16, v38
    v_add_u32 v38, s36, v38
    v_add_u32 v39, 192, v1
    v_mul_u32_u24 v39, 16, v39
    v_add_u32 v39, s36, v39
    s_mov_b32 s60, 0
L_b2_poll:
    global_load_dword v40, v36, s[30:31] sc1
    global_load_dword v41, v37, s[30:31] sc1
    global_load_dword v42, v38, s[30:31] sc1
    global_load_dword v43, v39, s[30:31] sc1
    s_waitcnt vmcnt(0)
    v_cmp_ne_u32 vcc, s7, v40
    v_cmp_ne_u32 s[36:37], s7, v41
    s_or_b64 vcc, vcc, s[36:37]
    v_cmp_ne_u32 s[36:37], s7, v42
    s_or_b64 vcc, vcc, s[36:37]
    v_cmp_ne_u32 s[36:37], s7, v43
    s_or_b64 vcc, vcc, s[36:37]
    s_cbranch_vccz L_b2_done
    s_add_u32 s60, s60, 1
    s_cmp_le_u32 s60, 20000
    s_cbranch_scc1 L_b2_poll
L_b2_done:
    s_cmp_lg_u32 s2, 0
    s_cbranch_scc1 L_noepoch
    v_mov_b32 v2, 0
    v_mov_b32 v3, s7
    s_mov_b64 exec, 1
    global_store_dword v2, v3, s[30:31] sc1
    s_mov_b64 exec, -1
L_noepoch:
    s_barrier
    global_load_lds_dwordx4 v5, s[62:63] offset:0 sc1
    global_load_lds_dwordx4 v5, s[62:63] offset:1024 sc1
    global_load_lds_dwordx4 v5, s[62:63] offset:2048 sc1
    global_load_lds_dwordx4 v5, s[62:63] offset:3072 sc1
    s_add_u32 m0, m0, 4096
    s_nop 0
    global_load_lds_dwordx4 v5, s[64:65] offset:0 sc1
    global_load_lds_dwordx4 v5, s[64:65] offset:1024 sc1
    global_load_lds_dwordx4 v5, s[64:65] offset:2048 sc1
    v_mfma_f32_32x32x16_bf16 v[16:31], a[72:75], v[32:35], v[16:31]
    v_mfma_f32_32x32x16_bf16 v[16:31], a[76:79], v[32:35], v[16:31]
    v_mfma_f32_32x32x16_bf16 v[16:31], a[80:83], v[32:35], v[16:31]
    v_mfma_f32_32x32x16_bf16 v[16:31], a[84:87], v[32:35], v[16:31]
    v_mfma_f32_32x32x16_bf16 v[16:31], a[88:91], v[32:35], v[16:31]
    v_mfma_f32_32x32x16_bf16 v[16:31], a[92:95], v[32:35], v[16:31]
    v_mfma_f32_32x32x16_bf16 v[16:31], a[96:99], v[32:35], v[16:31]
    v_mfma_f32_32x32x16_bf16 v[16:31], a[100:103], v[32:35], v[16:31]
    v_mfma_f32_32x32x16_bf16 v[16:31], a[104:107], v[32:35], v[16:31]
    v_mfma_f32_32x32x16_bf16 v[16:31], a[108:111], v[32:35], v[16:31]
    s_branch L_b2x
L_b2w:
    s_waitcnt vmcnt(0)
    v_mfma_f32_32x32x16_bf16 v[16:31], a[72:75], v[32:35], v[16:31]
    v_mfma_f32_32x32x16_bf16 v[16:31], a[76:79], v[32:35], v[16:31]
    v_mfma_f32_32x32x16_bf16 v[16:31], a[80:83], v[32:35], v[16:31]
    v_mfma_f32_32x32x16_bf16 v[16:31], a[84:87], v[32:35], v[16:31]
    v_mfma_f32_32x32x16_bf16 v[16:31], a[88:91], v[32:35], v[16:31]
    v_mfma_f32_32x32x16_bf16 v[16:31], a[92:95], v[32:35], v[16:31]
    v_mfma_f32_32x32x16_bf16 v[16:31], a[96:99], v[32:35], v[16:31]
    v_mfma_f32_32x32x16_bf16 v[16:31], a[100:103], v[32:35], v[16:31]
    v_mfma_f32_32x32x16_bf16 v[16:31], a[104:107], v[32:35], v[16:31]
    v_mfma_f32_32x32x16_bf16 v[16:31], a[108:111], v[32:35], v[16:31]
    s_barrier
    global_load_lds_dwordx4 v5, s[62:63] offset:0 sc1
    global_load_lds_dwordx4 v5, s[62:63] offset:1024 sc1
    global_load_lds_dwordx4 v5, s[62:63] offset:2048 sc1
    global_load_lds_dwordx4 v5, s[62:63] offset:3072 sc1
    s_add_u32 m0, m0, 4096
    s_nop 0
    global_load_lds_dwordx4 v5, s[64:65] offset:0 sc1
    global_load_lds_dwordx4 v5, s[64:65] offset:1024 sc1
    global_load_lds_dwordx4 v5, s[64:65] offset:2048 sc1
L_b2x:
    v_lshrrev_b32 v2, 5, v1
    v_lshlrev_b32 v2, 10, v2
    v_bfe_u32 v3, v1, 2, 2
    v_lshl_add_u32 v2, v3, 7, v2
    v_bfe_u32 v3, v1, 4, 1
    v_lshl_add_u32 v2, v3, 5, v2
    v_and_b32 v3, 3, v1
    v_lshl_add_u32 v2, v3, 3, v2
    v_bfe_u32 v3, v1, 3, 1
    v_lshlrev_b32 v3, 6, v3
    v_xor_b32 v2, v2, v3
    s_lshl_b32 s36, s6, 13
    s_lshl_b32 s37, s3, 11
    s_and_b32 s37, s37, 0x1000
    s_add_u32 s36, s36, s37
    s_lshl_b32 s37, s3, 11
    s_and_b32 s37, s37, 0x800
    s_add_u32 s36, s36, s37
    s_lshl_b32 s37, s3, 4
    s_and_b32 s37, s37, 64
    v_xor_b32 v15, s37, v2
    v_and_b32 v3, 0xfffffbff, v15
    v_lshrrev_b32 v4, 5, v1
    v_lshl_add_u32 v15, v4, 9, v3
    v_add_u32 v15, s36, v15
    s_and_b32 s40, s3, 1
    s_lshl_b32 s37, s40, 6
    v_xor_b32 v2, s37, v2
    s_lshr_b32 s41, s3, 1
    s_add_u32 s38, s41, 0
    s_and_b32 s38, s38, 3
    s_mul_i32 s44, s38, 14336
    s_add_u32 s38, s41, 1
    s_and_b32 s38, s38, 3
    s_mul_i32 s45, s38, 14336
    s_add_u32 s38, s41, 2
    s_and_b32 s38, s38, 3
    s_mul_i32 s46, s38, 14336
    s_add_u32 s38, s41, 3
    s_and_b32 s38, s38, 3
    s_mul_i32 s47, s38, 14336
    v_and_b32 v3, 31, v1
    v_lshlrev_b32 v3, 3, v3
    s_lshl_b32 s38, s40, 10
    s_add_u32 s38, s38, 57344
    v_add_u32 v4, s38, v3
    s_lshl_b32 s39, s41, 8
    v_add_u32 v3, s39, v4
    s_lshl_b32 s36, s5, 1
    s_add_u32 s36, s36, s40
    s_mul_i32 s36, s36, 112
    s_lshl_b32 s37, s61, 1
    s_add_u32 s36, s36, s37
    s_lshl_b32 s36, s36, 10
    s_add_u32 s36, s36, 8388608
    s_add_u32 s62, s30, s36
    s_addc_u32 s63, s31, 0
    s_mul_i32 s37, s40, -229376
    s_add_u32 s37, s37, 114688
    s_add_u32 s36, s36, s37
    s_add_u32 s64, s30, s36
    s_addc_u32 s65, s31, 0
    v_mov_b32 v8, 0
    v_mov_b32 v9, 0
    v_mov_b32 v10, 0
    v_mov_b32 v11, 0
    s_mov_b32 s48, 0xbfb8aa3b
    s_mov_b32 s49, 0x3f803f80
    s_mul_i32 s36, s6, 224
    s_mul_i32 s37, s3, 14
    s_add_u32 s36, s36, s37
    s_lshl_b32 s36, s36, 10
    s_add_u32 s36, s36, 3145728
    s_mul_i32 s59, s3, 12288
    s_add_u32 s59, s59, 65536
    v_add_u32 v14, s59, v5
    s_add_u32 s38, s36, 3072
    s_add_u32 s8, s30, s38
    s_addc_u32 s9, s31, 0
    s_add_u32 s38, s36, 10240
    s_add_u32 s10, s30, s38
    s_addc_u32 s11, s31, 0
    s_add_u32 s38, s36, 117760
    s_add_u32 s12, s30, s38
    s_addc_u32 s13, s31, 0
    s_add_u32 s38, s36, 124928
    s_add_u32 s14, s30, s38
    s_addc_u32 s15, s31, 0
    s_add_u32 s38, s36, 8192
    s_add_u32 s16, s30, s38
    s_addc_u32 s17, s31, 0
    s_add_u32 s38, s36, 12288
    s_add_u32 s18, s30, s38
    s_addc_u32 s19, s31, 0
    s_add_u32 s38, s36, 122880
    s_add_u32 s20, s30, s38
    s_addc_u32 s21, s31, 0
    s_add_u32 s38, s36, 126976
    s_add_u32 s22, s30, s38
    s_addc_u32 s23, s31, 0
    s_waitcnt vmcnt(0)
    s_barrier
    v_add_u32 v6, s44, v2
    ds_read_b64_tr_b16 v[64:65], v6 offset:0
    ds_read_b64_tr_b16 v[66:67], v6 offset:512
    ds_read_b64_tr_b16 v[68:69], v6 offset:2048
    ds_read_b64_tr_b16 v[70:71], v6 offset:2560
    ds_read_b64_tr_b16 v[72:73], v6 offset:4096
    ds_read_b64_tr_b16 v[74:75], v6 offset:4608
    ds_read_b64_tr_b16 v[76:77], v6 offset:6144
    ds_read_b64_tr_b16 v[78:79], v6 offset:6656
    ds_read_b64_tr_b16 v[80:81], v6 offset:8192
    ds_read_b64_tr_b16 v[82:83], v6 offset:8704
    ds_read_b64_tr_b16 v[84:85], v6 offset:10240
    ds_read_b64_tr_b16 v[86:87], v6 offset:10752
    ds_read_b64_tr_b16 v[88:89], v6 offset:12288
    ds_read_b64_tr_b16 v[90:91], v6 offset:12800
    s_waitcnt lgkmcnt(12)
    v_mfma_f32_32x32x16_bf16 v[32:47], a[0:3], v[64:67], 0
    v_dot2c_f32_bf16 v8, s49, v64
    v_dot2c_f32_bf16 v10, v64, v64
    v_dot2c_f32_bf16 v9, s49, v65
    v_dot2c_f32_bf16 v11, v65, v65
    v_dot2c_f32_bf16 v8, s49, v66
    v_dot2c_f32_bf16 v10, v66, v66
    v_dot2c_f32_bf16 v9, s49, v67
    v_dot2c_f32_bf16 v11, v67, v67
    v_add_u32 v7, s45, v2
    ds_read_b64_tr_b16 v[64:65], v7 offset:0
    ds_read_b64_tr_b16 v[66:67], v7 offset:512
    s_waitcnt lgkmcnt(12)
    v_mfma_f32_32x32x16_bf16 v[32:47], a[4:7], v[68:71], v[32:47]
    v_dot2c_f32_bf16 v8, s49, v68
    v_dot2c_f32_bf16 v10, v68, v68
    v_dot2c_f32_bf16 v9, s49, v69
    v_dot2c_f32_bf16 v11, v69, v69
    v_dot2c_f32_bf16 v8, s49, v70
    v_dot2c_f32_bf16 v10, v70, v70
    v_dot2c_f32_bf16 v9, s49, v71
    v_dot2c_f32_bf16 v11, v71, v71
    s_add_u32 m0, s59, 0
    s_nop 0
    global_load_lds_dwordx4 v5, s[16:17] offset:0 sc1
    ds_read_b64_tr_b16 v[68:69], v7 offset:2048
    ds_read_b64_tr_b16 v[70:71], v7 offset:2560
    s_waitcnt lgkmcnt(12)
    v_mfma_f32_32x32x16_bf16 v[32:47], a[8:11], v[72:75], v[32:47]
    v_dot2c_f32_bf16 v8, s49, v72
    v_dot2c_f32_bf16 v10, v72, v72
    v_dot2c_f32_bf16 v9, s49, v73
    v_dot2c_f32_bf16 v11, v73, v73
    v_dot2c_f32_bf16 v8, s49, v74
    v_dot2c_f32_bf16 v10, v74, v74
    v_dot2c_f32_bf16 v9, s49, v75
    v_dot2c_f32_bf16 v11, v75, v75
    ds_read_b64_tr_b16 v[72:73], v7 offset:4096
    ds_read_b64_tr_b16 v[74:75], v7 offset:4608
    s_waitcnt lgkmcnt(12)
    v_mfma_f32_32x32x16_bf16 v[32:47], a[12:15], v[76:79], v[32:47]
    v_dot2c_f32_bf16 v8, s49, v76
    v_dot2c_f32_bf16 v10, v76, v76
    v_dot2c_f32_bf16 v9, s49, v77
    v_dot2c_f32_bf16 v11, v77, v77
    v_dot2c_f32_bf16 v8, s49, v78
    v_dot2c_f32_bf16 v10, v78, v78
    v_dot2c_f32_bf16 v9, s49, v79
    v_dot2c_f32_bf16 v11, v79, v79
    global_load_lds_dwordx4 v5, s[16:17] offset:1024 sc1
    ds_read_b64_tr_b16 v[76:77], v7 offset:6144
    ds_read_b64_tr_b16 v[78:79], v7 offset:6656
    s_waitcnt lgkmcnt(12)
    v_mfma_f32_32x32x16_bf16 v[32:47], a[16:19], v[80:83], v[32:47]
    v_dot2c_f32_bf16 v8, s49, v80
    v_dot2c_f32_bf16 v10, v80, v80
    v_dot2c_f32_bf16 v9, s49, v81
    v_dot2c_f32_bf16 v11, v81, v81
    v_dot2c_f32_bf16 v8, s49, v82
    v_dot2c_f32_bf16 v10, v82, v82
    v_dot2c_f32_bf16 v9, s49, v83
    v_dot2c_f32_bf16 v11, v83, v83
    ds_read_b64_tr_b16 v[80:81], v7 offset:8192
    ds_read_b64_tr_b16 v[82:83], v7 offset:8704
    s_waitcnt lgkmcnt(12)
    v_mfma_f32_32x32x16_bf16 v[32:47], a[20:23], v[84:87], v[32:47]
    v_dot2c_f32_bf16 v8, s49, v84
    v_dot2c_f32_bf16 v10, v84, v84
    v_dot2c_f32_bf16 v9, s49, v85
    v_dot2c_f32_bf16 v11, v85, v85
    v_dot2c_f32_bf16 v8, s49, v86
    v_dot2c_f32_bf16 v10, v86, v86
    v_dot2c_f32_bf16 v9, s49, v87
    v_dot2c_f32_bf16 v11, v87, v87
    global_load_lds_dwordx4 v5, s[16:17] offset:2048 sc1
    ds_read_b64_tr_b16 v[84:85], v7 offset:10240
    ds_read_b64_tr_b16 v[86:87], v7 offset:10752
    s_waitcnt lgkmcnt(12)
    v_mfma_f32_32x32x16_bf16 v[32:47], a[24:27], v[88:91], v[32:47]
    v_dot2c_f32_bf16 v8, s49, v88
    v_dot2c_f32_bf16 v10, v88, v88
    v_dot2c_f32_bf16 v9, s49, v89
    v_dot2c_f32_bf16 v11, v89, v89
    v_dot2c_f32_bf16 v8, s49, v90
    v_dot2c_f32_bf16 v10, v90, v90
    v_dot2c_f32_bf16 v9, s49, v91
    v_dot2c_f32_bf16 v11, v91, v91
    ds_read_b64_tr_b16 v[88:89], v7 offset:12288
    ds_read_b64_tr_b16 v[90:91], v7 offset:12800
    s_waitcnt lgkmcnt(12)
    v_mfma_f32_32x32x16_bf16 v[32:47], a[28:31], v[64:67], v[32:47]
    v_add_f32 v8, v8, v9
    v_add_f32 v9, v10, v11
    v_mov_b32 v10, v8
    v_mov_b32 v11, v9
    s_nop 0
    v_permlane32_swap_b32 v8, v10
    v_permlane32_swap_b32 v9, v11
    v_add_f32 v8, v8, v10
    v_add_f32 v9, v9, v11
    ds_write_b64 v3, v[8:9]
    v_xor_b32 v13, 1024, v4
    ds_read_b64_tr_b16 v[112:113], v15
    ds_read_b64_tr_b16 v[114:115], v15 offset:1024
    global_load_lds_dwordx4 v5, s[16:17] offset:3072 sc1
    v_add_u32 v6, s46, v2
    ds_read_b64_tr_b16 v[64:65], v6 offset:0
    ds_read_b64_tr_b16 v[66:67], v6 offset:512
    s_waitcnt lgkmcnt(15)
    v_mfma_f32_32x32x16_bf16 v[32:47], a[32:35], v[68:71], v[32:47]
    ds_read_b64_tr_b16 v[68:69], v6 offset:2048
    ds_read_b64_tr_b16 v[70:71], v6 offset:2560
    s_waitcnt lgkmcnt(15)
    v_mfma_f32_32x32x16_bf16 v[32:47], a[36:39], v[72:75], v[32:47]
    s_add_u32 m0, s59, 4096
    s_nop 0
    global_load_lds_dwordx4 v5, s[18:19] offset:0 sc1
    ds_read_b64_tr_b16 v[72:73], v6 offset:4096
    ds_read_b64_tr_b16 v[74:75], v6 offset:4608
    s_waitcnt lgkmcnt(15)
    v_mfma_f32_32x32x16_bf16 v[32:47], a[40:43], v[76:79], v[32:47]
    ds_read_b64_tr_b16 v[76:77], v6 offset:6144
    ds_read_b64_tr_b16 v[78:79], v6 offset:6656
    s_waitcnt lgkmcnt(15)
    v_mfma_f32_32x32x16_bf16 v[32:47], a[44:47], v[80:83], v[32:47]
    global_load_lds_dwordx4 v5, s[18:19] offset:1024 sc1
    ds_read_b64_tr_b16 v[80:81], v6 offset:8192
    ds_read_b64_tr_b16 v[82:83], v6 offset:8704
    s_waitcnt lgkmcnt(15)
    v_mfma_f32_32x32x16_bf16 v[32:47], a[48:51], v[84:87], v[32:47]
    ds_read_b64_tr_b16 v[84:85], v6 offset:10240
    ds_read_b64_tr_b16 v[86:87], v6 offset:10752
    s_waitcnt lgkmcnt(15)
    v_mfma_f32_32x32x16_bf16 v[32:47], a[52:55], v[88:91], v[32:47]
    s_waitcnt lgkmcnt(12)
    s_add_u32 m0, s59, 6144
    s_nop 0
    global_load_lds_dwordx4 v5, s[20:21] offset:0 sc1
    s_barrier
    ds_read_b64 v[96:97], v4 offset:0
    ds_read_b64 v[98:99], v4 offset:256
    ds_read_b64 v[100:101], v4 offset:512
    ds_read_b64 v[102:103], v4 offset:768
    ds_read_b64 v[104:105], v13 offset:0
    ds_read_b64 v[106:107], v13 offset:256
    ds_read_b64 v[108:109], v13 offset:512
    ds_read_b64 v[110:111], v13 offset:768
    ds_read_b64_tr_b16 v[88:89], v6 offset:12288
    ds_read_b64_tr_b16 v[90:91], v6 offset:12800
    s_waitcnt lgkmcnt(15)
    v_mfma_f32_32x32x16_bf16 v[32:47], a[56:59], v[64:67], v[32:47]
    v_add_u32 v7, s47, v2
    ds_read_b64_tr_b16 v[64:65], v7 offset:0
    ds_read_b64_tr_b16 v[66:67], v7 offset:512
    v_mfma_f32_32x32x16_bf16 v[32:47], a[60:63], v[68:71], v[32:47]
    global_load_lds_dwordx4 v5, s[20:21] offset:1024 sc1
    ds_read_b64_tr_b16 v[68:69], v7 offset:2048
    ds_read_b64_tr_b16 v[70:71], v7 offset:2560
    s_waitcnt lgkmcnt(6)
    v_mfma_f32_32x32x16_bf16 v[32:47], a[64:67], v[72:75], v[32:47]
    v_add_f32 v96, v96, v98
    v_add_f32 v97, v97, v99
    v_add_f32 v100, v100, v102
    v_add_f32 v101, v101, v103
    ds_read_b64_tr_b16 v[72:73], v7 offset:4096
    ds_read_b64_tr_b16 v[74:75], v7 offset:4608
    v_mfma_f32_32x32x16_bf16 v[32:47], a[68:71], v[76:79], v[32:47]
    v_add_f32 v96, v96, v100
    v_add_f32 v97, v97, v101
    v_mul_f32 v96, 0x3b124925, v96
    v_mul_f32 v97, 0x3b124925, v97
    global_load_lds_dwordx4 v5, s[20:21] offset:2048 sc1
    ds_read_b64_tr_b16 v[76:77], v7 offset:6144
    ds_read_b64_tr_b16 v[78:79], v7 offset:6656
    v_mfma_f32_32x32x16_bf16 v[32:47], a[72:75], v[80:83], v[32:47]
    v_fma_f32 v97, -v96, v96, v97
    v_max_f32 v97, 0, v97
    v_cvt_pk_bf16_f32 v98, v96, v97
    ds_read_b64_tr_b16 v[80:81], v7 offset:8192
    ds_read_b64_tr_b16 v[82:83], v7 offset:8704
    v_mfma_f32_32x32x16_bf16 v[32:47], a[76:79], v[84:87], v[32:47]
    v_lshlrev_b32 v96, 16, v98
    v_and_b32 v98, 0xffff0000, v98
    v_add_f32 v98, 0x3727c5ac, v98
    v_cvt_pk_bf16_f32 v98, v98, v98
    global_load_lds_dwordx4 v5, s[20:21] offset:3072 sc1
    ds_read_b64_tr_b16 v[84:85], v7 offset:10240
    ds_read_b64_tr_b16 v[86:87], v7 offset:10752
    s_waitcnt lgkmcnt(12)
    v_mfma_f32_32x32x16_bf16 v[32:47], a[80:83], v[88:91], v[32:47]
    v_and_b32 v98, 0xffff0000, v98
    v_sqrt_f32 v98, v98
    s_nop 0
    v_cvt_pk_bf16_f32 v99, v98, v98
    v_and_b32 v99, 0xffff0000, v99
    ds_read_b64_tr_b16 v[88:89], v7 offset:12288
    ds_read_b64_tr_b16 v[90:91], v7 offset:12800
    s_waitcnt lgkmcnt(12)
    v_mfma_f32_32x32x16_bf16 v[32:47], a[84:87], v[64:67], v[32:47]
    v_rcp_f32 v97, v99
    v_mul_f32 v96, -1.0, v96
    v_mul_f32 v98, s48, v97
    s_add_u32 m0, s59, 10240
    s_nop 0
    global_load_lds_dwordx4 v5, s[22:23] offset:0 sc1
    v_add_u32 v6, s44, v2
    v_xor_b32 v6, 64, v6
    ds_read_b64_tr_b16 v[64:65], v6 offset:0
    ds_read_b64_tr_b16 v[66:67], v6 offset:512
    s_waitcnt lgkmcnt(12)
    v_mfma_f32_32x32x16_bf16 v[32:47], a[88:91], v[68:71], v[32:47]
    v_add_f32 v104, v104, v106
    v_add_f32 v105, v105, v107
    v_add_f32 v108, v108, v110
    v_add_f32 v109, v109, v111
    ds_read_b64_tr_b16 v[68:69], v6 offset:2048
    ds_read_b64_tr_b16 v[70:71], v6 offset:2560
    s_waitcnt lgkmcnt(12)
    v_mfma_f32_32x32x16_bf16 v[32:47], a[92:95], v[72:75], v[32:47]
    v_add_f32 v104, v104, v108
    v_add_f32 v105, v105, v109
    v_mul_f32 v104, 0x3b124925, v104
    v_mul_f32 v105, 0x3b124925, v105
    global_load_lds_dwordx4 v5, s[22:23] offset:1024 sc1
    ds_read_b64_tr_b16 v[72:73], v6 offset:4096
    ds_read_b64_tr_b16 v[74:75], v6 offset:4608
    s_waitcnt lgkmcnt(12)
    v_mfma_f32_32x32x16_bf16 v[32:47], a[96:99], v[76:79], v[32:47]
    v_fma_f32 v105, -v104, v104, v105
    v_max_f32 v105, 0, v105
    v_cvt_pk_bf16_f32 v106, v104, v105
    ds_read_b64_tr_b16 v[76:77], v6 offset:6144
    ds_read_b64_tr_b16 v[78:79], v6 offset:6656
    s_waitcnt lgkmcnt(12)
    v_mfma_f32_32x32x16_bf16 v[32:47], a[100:103], v[80:83], v[32:47]
    v_lshlrev_b32 v104, 16, v106
    v_and_b32 v106, 0xffff0000, v106
    v_add_f32 v106, 0x3727c5ac, v106
    v_cvt_pk_bf16_f32 v106, v106, v106
    ds_read_b64_tr_b16 v[80:81], v6 offset:8192
    ds_read_b64_tr_b16 v[82:83], v6 offset:8704
    s_waitcnt lgkmcnt(12)
    v_mfma_f32_32x32x16_bf16 v[32:47], a[104:107], v[84:87], v[32:47]
    v_and_b32 v106, 0xffff0000, v106
    v_sqrt_f32 v106, v106
    s_nop 0
    v_cvt_pk_bf16_f32 v107, v106, v106
    v_and_b32 v107, 0xffff0000, v107
    ds_read_b64_tr_b16 v[84:85], v6 offset:10240
    ds_read_b64_tr_b16 v[86:87], v6 offset:10752
    s_waitcnt lgkmcnt(12)
    v_mfma_f32_32x32x16_bf16 v[32:47], a[108:111], v[88:91], v[32:47]
    v_rcp_f32 v105, v107
    v_mul_f32 v104, -1.0, v104
    v_mul_f32 v106, s48, v105
    ds_read_b64_tr_b16 v[88:89], v6 offset:12288
    ds_read_b64_tr_b16 v[90:91], v6 offset:12800
    s_waitcnt lgkmcnt(12)
    v_mfma_f32_32x32x16_bf16 v[48:63], a[0:3], v[64:67], 0
    s_nop 4
    v_fma_f32 v32, v96, v16, v32
    v_fma_f32 v33, v96, v17, v33
    v_fma_f32 v34, v96, v18, v34
    v_fma_f32 v35, v96, v19, v35
    v_mul_f32 v32, v98, v32
    v_add_u32 v7, s45, v2
    v_xor_b32 v7, 64, v7
    ds_read_b64_tr_b16 v[64:65], v7 offset:0
    ds_read_b64_tr_b16 v[66:67], v7 offset:512
    s_waitcnt lgkmcnt(12)
    v_mfma_f32_32x32x16_bf16 v[48:63], a[4:7], v[68:71], v[48:63]
    v_mul_f32 v33, v98, v33
    v_mul_f32 v34, v98, v34
    v_mul_f32 v35, v98, v35
    v_exp_f32 v116, v32
    global_load_dwordx4 a[0:3], v5, s[8:9] offset:-3072 sc1
    ds_read_b64_tr_b16 v[68:69], v7 offset:2048
    ds_read_b64_tr_b16 v[70:71], v7 offset:2560
    s_waitcnt lgkmcnt(12)
    v_mfma_f32_32x32x16_bf16 v[48:63], a[8:11], v[72:75], v[48:63]
    v_exp_f32 v117, v33
    v_exp_f32 v118, v34
    v_exp_f32 v119, v35
    v_fma_f32 v116, v116, s48, s48
    v_fma_f32 v117, v117, s48, s48
    ds_read_b64_tr_b16 v[72:73], v7 offset:4096
    ds_read_b64_tr_b16 v[74:75], v7 offset:4608
    s_waitcnt lgkmcnt(12)
    v_mfma_f32_32x32x16_bf16 v[48:63], a[12:15], v[76:79], v[48:63]
    v_fma_f32 v118, v118, s48, s48
    v_fma_f32 v119, v119, s48, s48
    v_rcp_f32 v116, v116
    v_rcp_f32 v117, v117
    global_load_dwordx4 a[4:7], v5, s[12:13] offset:-3072 sc1
    ds_read_b64_tr_b16 v[76:77], v7 offset:6144
    ds_read_b64_tr_b16 v[78:79], v7 offset:6656
    s_waitcnt lgkmcnt(12)
    v_mfma_f32_32x32x16_bf16 v[48:63], a[16:19], v[80:83], v[48:63]
    v_rcp_f32 v118, v118
    v_rcp_f32 v119, v119
    v_mul_f32 v32, v32, v116
    v_mul_f32 v33, v33, v117
    v_mul_f32 v34, v34, v118
    ds_read_b64_tr_b16 v[80:81], v7 offset:8192
    ds_read_b64_tr_b16 v[82:83], v7 offset:8704
    s_waitcnt lgkmcnt(12)
    v_mfma_f32_32x32x16_bf16 v[48:63], a[20:23], v[84:87], v[48:63]
    v_mul_f32 v35, v35, v119
    v_cvt_pk_bf16_f32 v128, v32, v33
    v_cvt_pk_bf16_f32 v129, v34, v35
    v_fma_f32 v36, v96, v20, v36
    global_load_dwordx4 a[8:11], v5, s[8:9] offset:-2048 sc1
    ds_read_b64_tr_b16 v[84:85], v7 offset:10240
    ds_read_b64_tr_b16 v[86:87], v7 offset:10752
    s_waitcnt lgkmcnt(12)
    v_mfma_f32_32x32x16_bf16 v[48:63], a[24:27], v[88:91], v[48:63]
    v_fma_f32 v37, v96, v21, v37
    v_fma_f32 v38, v96, v22, v38
    v_fma_f32 v39, v96, v23, v39
    v_mul_f32 v36, v98, v36
    ds_read_b64_tr_b16 v[88:89], v7 offset:12288
    ds_read_b64_tr_b16 v[90:91], v7 offset:12800
    s_waitcnt lgkmcnt(12)
    v_mfma_f32_32x32x16_bf16 v[48:63], a[28:31], v[64:67], v[48:63]
    v_mul_f32 v37, v98, v37
    v_mul_f32 v38, v98, v38
    v_mul_f32 v39, v98, v39
    v_exp_f32 v116, v36
    v_exp_f32 v117, v37
    global_load_dwordx4 a[12:15], v5, s[12:13] offset:-2048 sc1
    v_add_u32 v6, s46, v2
    v_xor_b32 v6, 64, v6
    ds_read_b64_tr_b16 v[64:65], v6 offset:0
    ds_read_b64_tr_b16 v[66:67], v6 offset:512
    s_waitcnt lgkmcnt(12)
    v_mfma_f32_32x32x16_bf16 v[48:63], a[32:35], v[68:71], v[48:63]
    v_exp_f32 v118, v38
    v_exp_f32 v119, v39
    v_fma_f32 v116, v116, s48, s48
    v_fma_f32 v117, v117, s48, s48
    ds_read_b64_tr_b16 v[68:69], v6 offset:2048
    ds_read_b64_tr_b16 v[70:71], v6 offset:2560
    s_waitcnt lgkmcnt(12)
    v_mfma_f32_32x32x16_bf16 v[48:63], a[36:39], v[72:75], v[48:63]
    v_fma_f32 v118, v118, s48, s48
    v_fma_f32 v119, v119, s48, s48
    v_rcp_f32 v116, v116
    v_rcp_f32 v117, v117
    v_rcp_f32 v118, v118
    global_load_dwordx4 a[16:19], v5, s[8:9] offset:-1024 sc1
    ds_read_b64_tr_b16 v[72:73], v6 offset:4096
    ds_read_b64_tr_b16 v[74:75], v6 offset:4608
    s_waitcnt lgkmcnt(12)
    v_mfma_f32_32x32x16_bf16 v[48:63], a[40:43], v[76:79], v[48:63]
    v_rcp_f32 v119, v119
    v_mul_f32 v36, v36, v116
    v_mul_f32 v37, v37, v117
    v_mul_f32 v38, v38, v118
    ds_read_b64_tr_b16 v[76:77], v6 offset:6144
    ds_read_b64_tr_b16 v[78:79], v6 offset:6656
    s_waitcnt lgkmcnt(12)
    v_mfma_f32_32x32x16_bf16 v[48:63], a[44:47], v[80:83], v[48:63]
    v_mul_f32 v39, v39, v119
    v_cvt_pk_bf16_f32 v130, v36, v37
    v_cvt_pk_bf16_f32 v131, v38, v39
    global_store_dwordx4 v5, v[128:131], s[62:63] offset:0 sc1
    global_load_dwordx4 a[20:23], v5, s[12:13] offset:-1024 sc1
    ds_read_b64_tr_b16 v[80:81], v6 offset:8192
    ds_read_b64_tr_b16 v[82:83], v6 offset:8704
    s_waitcnt lgkmcnt(12)
    v_mfma_f32_32x32x16_bf16 v[48:63], a[48:51], v[84:87], v[48:63]
    v_fma_f32 v40, v96, v24, v40
    v_fma_f32 v41, v96, v25, v41
    v_fma_f32 v42, v96, v26, v42
    v_fma_f32 v43, v96, v27, v43
    v_mul_f32 v40, v98, v40
    ds_read_b64_tr_b16 v[84:85], v6 offset:10240
    ds_read_b64_tr_b16 v[86:87], v6 offset:10752
    s_waitcnt lgkmcnt(12)
    v_mfma_f32_32x32x16_bf16 v[48:63], a[52:55], v[88:91], v[48:63]
    v_mul_f32 v41, v98, v41
    v_mul_f32 v42, v98, v42
    v_mul_f32 v43, v98, v43
    v_exp_f32 v116, v40
    global_load_dwordx4 a[24:27], v5, s[8:9] offset:0 sc1
    ds_read_b64_tr_b16 v[88:89], v6 offset:12288
    ds_read_b64_tr_b16 v[90:91], v6 offset:12800
    s_waitcnt lgkmcnt(12)
    v_mfma_f32_32x32x16_bf16 v[48:63], a[56:59], v[64:67], v[48:63]
    v_exp_f32 v117, v41
    v_exp_f32 v118, v42
    v_exp_f32 v119, v43
    v_fma_f32 v116, v116, s48, s48
    v_fma_f32 v117, v117, s48, s48
    v_add_u32 v7, s47, v2
    v_xor_b32 v7, 64, v7
    ds_read_b64_tr_b16 v[64:65], v7 offset:0
    ds_read_b64_tr_b16 v[66:67], v7 offset:512
    s_waitcnt lgkmcnt(12)
    v_mfma_f32_32x32x16_bf16 v[48:63], a[60:63], v[68:71], v[48:63]
    v_fma_f32 v118, v118, s48, s48
    v_fma_f32 v119, v119, s48, s48
    v_rcp_f32 v116, v116
    v_rcp_f32 v117, v117
    global_load_dwordx4 a[28:31], v5, s[12:13] offset:0 sc1
    ds_read_b64_tr_b16 v[68:69], v7 offset:2048
    ds_read_b64_tr_b16 v[70:71], v7 offset:2560
    s_waitcnt lgkmcnt(12)
    v_mfma_f32_32x32x16_bf16 v[48:63], a[64:67], v[72:75], v[48:63]
    v_rcp_f32 v118, v118
    v_rcp_f32 v119, v119
    v_mul_f32 v40, v40, v116
    v_mul_f32 v41, v41, v117
    v_mul_f32 v42, v42, v118
    ds_read_b64_tr_b16 v[72:73], v7 offset:4096
    ds_read_b64_tr_b16 v[74:75], v7 offset:4608
    s_waitcnt lgkmcnt(12)
    v_mfma_f32_32x32x16_bf16 v[48:63], a[68:71], v[76:79], v[48:63]
    v_mul_f32 v43, v43, v119
    v_cvt_pk_bf16_f32 v132, v40, v41
    v_cvt_pk_bf16_f32 v133, v42, v43
    v_fma_f32 v44, v96, v28, v44
    global_load_dwordx4 a[32:35], v5, s[8:9] offset:1024 sc1
    ds_read_b64_tr_b16 v[76:77], v7 offset:6144
    ds_read_b64_tr_b16 v[78:79], v7 offset:6656
    s_waitcnt lgkmcnt(12)
    v_mfma_f32_32x32x16_bf16 v[48:63], a[72:75], v[80:83], v[48:63]
    v_fma_f32 v45, v96, v29, v45
    v_fma_f32 v46, v96, v30, v46
    v_fma_f32 v47, v96, v31, v47
    v_mul_f32 v44, v98, v44
    ds_read_b64_tr_b16 v[80:81], v7 offset:8192
    ds_read_b64_tr_b16 v[82:83], v7 offset:8704
    s_waitcnt lgkmcnt(12)
    v_mfma_f32_32x32x16_bf16 v[48:63], a[76:79], v[84:87], v[48:63]
    v_mul_f32 v45, v98, v45
    v_mul_f32 v46, v98, v46
    v_mul_f32 v47, v98, v47
    v_exp_f32 v116, v44
    v_exp_f32 v117, v45
    global_load_dwordx4 a[36:39], v5, s[12:13] offset:1024 sc1
    ds_read_b64_tr_b16 v[84:85], v7 offset:10240
    ds_read_b64_tr_b16 v[86:87], v7 offset:10752
    s_waitcnt lgkmcnt(12)
    v_mfma_f32_32x32x16_bf16 v[48:63], a[80:83], v[88:91], v[48:63]
    v_exp_f32 v118, v46
    v_exp_f32 v119, v47
    v_fma_f32 v116, v116, s48, s48
    v_fma_f32 v117, v117, s48, s48
    ds_read_b64_tr_b16 v[88:89], v7 offset:12288
    ds_read_b64_tr_b16 v[90:91], v7 offset:12800
    s_waitcnt lgkmcnt(12)
    v_mfma_f32_32x32x16_bf16 v[48:63], a[84:87], v[64:67], v[48:63]
    v_fma_f32 v118, v118, s48, s48
    v_fma_f32 v119, v119, s48, s48
    v_rcp_f32 v116, v116
    v_rcp_f32 v117, v117
    v_rcp_f32 v118, v118
    global_load_dwordx4 a[40:43], v5, s[8:9] offset:2048 sc1
    s_waitcnt lgkmcnt(10)
    v_mfma_f32_32x32x16_bf16 v[48:63], a[88:91], v[68:71], v[48:63]
    v_rcp_f32 v119, v119
    v_mul_f32 v44, v44, v116
    v_mul_f32 v45, v45, v117
    v_mul_f32 v46, v46, v118
    s_waitcnt lgkmcnt(8)
    v_mfma_f32_32x32x16_bf16 v[48:63], a[92:95], v[72:75], v[48:63]
    v_mul_f32 v47, v47, v119
    v_cvt_pk_bf16_f32 v134, v44, v45
    v_cvt_pk_bf16_f32 v135, v46, v47
    global_store_dwordx4 v5, v[132:135], s[62:63] offset:1024 sc1
    global_load_dwordx4 a[44:47], v5, s[12:13] offset:2048 sc1
    s_waitcnt lgkmcnt(6)
    v_mfma_f32_32x32x16_bf16 v[48:63], a[96:99], v[76:79], v[48:63]
    s_waitcnt lgkmcnt(4)
    v_mfma_f32_32x32x16_bf16 v[48:63], a[100:103], v[80:83], v[48:63]
    global_load_dwordx4 a[48:51], v5, s[8:9] offset:3072 sc1
    s_waitcnt lgkmcnt(2)
    v_mfma_f32_32x32x16_bf16 v[48:63], a[104:107], v[84:87], v[48:63]
    s_waitcnt lgkmcnt(0)
    v_mfma_f32_32x32x16_bf16 v[48:63], a[108:111], v[88:91], v[48:63]
    global_load_dwordx4 a[52:55], v5, s[12:13] offset:3072 sc1
    s_mul_i32 s36, s5, 896
    s_add_u32 s36, s36, 524288
    s_lshl_b32 s37, s6, 7
    s_add_u32 s37, s37, s36
    v_mov_b32 v2, s37
    v_mov_b32 v3, s7
    v_min_u32 v4, 6, v1
    v_lshl_add_u32 v4, v4, 7, s36
    s_nop 2
    v_fma_f32 v48, v104, v16, v48
    v_fma_f32 v49, v104, v17, v49
    v_fma_f32 v50, v104, v18, v50
    v_fma_f32 v51, v104, v19, v51
    v_mul_f32 v48, v106, v48
    v_mul_f32 v49, v106, v49
    v_mul_f32 v50, v106, v50
    v_mul_f32 v51, v106, v51
    v_exp_f32 v116, v48
    v_exp_f32 v117, v49
    v_exp_f32 v118, v50
    v_exp_f32 v119, v51
    v_fma_f32 v116, v116, s48, s48
    global_load_dwordx4 a[56:59], v5, s[10:11] offset:-3072 sc1
    v_fma_f32 v117, v117, s48, s48
    v_fma_f32 v118, v118, s48, s48
    v_fma_f32 v119, v119, s48, s48
    v_rcp_f32 v116, v116
    v_rcp_f32 v117, v117
    v_rcp_f32 v118, v118
    v_rcp_f32 v119, v119
    v_mul_f32 v48, v48, v116
    v_mul_f32 v49, v49, v117
    v_mul_f32 v50, v50, v118
    v_mul_f32 v51, v51, v119
    v_cvt_pk_bf16_f32 v120, v48, v49
    v_cvt_pk_bf16_f32 v121, v50, v51
    global_load_dwordx4 a[60:63], v5, s[14:15] offset:-3072 sc1
    s_waitcnt vmcnt(18)
    v_fma_f32 v52, v104, v20, v52
    v_fma_f32 v53, v104, v21, v53
    v_fma_f32 v54, v104, v22, v54
    v_fma_f32 v55, v104, v23, v55
    v_mul_f32 v52, v106, v52
    v_mul_f32 v53, v106, v53
    v_mul_f32 v54, v106, v54
    ds_read_b128 a[64:67], v14 offset:0
    v_mul_f32 v55, v106, v55
    v_exp_f32 v116, v52
    v_exp_f32 v117, v53
    v_exp_f32 v118, v54
    v_exp_f32 v119, v55
    v_fma_f32 v116, v116, s48, s48
    v_fma_f32 v117, v117, s48, s48
    ds_read_b128 a[68:71], v14 offset:6144
    v_fma_f32 v118, v118, s48, s48
    v_fma_f32 v119, v119, s48, s48
    v_rcp_f32 v116, v116
    v_rcp_f32 v117, v117
    v_rcp_f32 v118, v118
    v_rcp_f32 v119, v119
    ds_read_b128 a[72:75], v14 offset:1024
    v_mul_f32 v52, v52, v116
    v_mul_f32 v53, v53, v117
    v_mul_f32 v54, v54, v118
    v_mul_f32 v55, v55, v119
    v_cvt_pk_bf16_f32 v122, v52, v53
    v_cvt_pk_bf16_f32 v123, v54, v55
    global_store_dwordx4 v5, v[120:123], s[64:65] offset:0 sc1
    ds_read_b128 a[76:79], v14 offset:7168
    v_fma_f32 v56, v104, v24, v56
    v_fma_f32 v57, v104, v25, v57
    v_fma_f32 v58, v104, v26, v58
    v_fma_f32 v59, v104, v27, v59
    v_mul_f32 v56, v106, v56
    v_mul_f32 v57, v106, v57
    v_mul_f32 v58, v106, v58
    ds_read_b128 a[80:83], v14 offset:2048
    v_mul_f32 v59, v106, v59
    v_exp_f32 v116, v56
    v_exp_f32 v117, v57
    v_exp_f32 v118, v58
    v_exp_f32 v119, v59
    v_fma_f32 v116, v116, s48, s48
    ds_read_b128 a[84:87], v14 offset:8192
    v_fma_f32 v117, v117, s48, s48
    v_fma_f32 v118, v118, s48, s48
    v_fma_f32 v119, v119, s48, s48
    v_rcp_f32 v116, v116
    v_rcp_f32 v117, v117
    v_rcp_f32 v118, v118
    v_rcp_f32 v119, v119
    ds_read_b128 a[88:91], v14 offset:3072
    v_mul_f32 v56, v56, v116
    v_mul_f32 v57, v57, v117
    v_mul_f32 v58, v58, v118
    v_mul_f32 v59, v59, v119
    v_cvt_pk_bf16_f32 v124, v56, v57
    v_cvt_pk_bf16_f32 v125, v58, v59
    v_fma_f32 v60, v104, v28, v60
    ds_read_b128 a[92:95], v14 offset:9216
    v_fma_f32 v61, v104, v29, v61
    v_fma_f32 v62, v104, v30, v62
    v_fma_f32 v63, v104, v31, v63
    v_mul_f32 v60, v106, v60
    v_mul_f32 v61, v106, v61
    v_mul_f32 v62, v106, v62
    ds_read_b128 a[96:99], v14 offset:4096
    v_mul_f32 v63, v106, v63
    v_exp_f32 v116, v60
    v_exp_f32 v117, v61
    v_exp_f32 v118, v62
    v_exp_f32 v119, v63
    v_fma_f32 v116, v116, s48, s48
    v_fma_f32 v117, v117, s48, s48
    ds_read_b128 a[100:103], v14 offset:10240
    v_fma_f32 v118, v118, s48, s48
    v_fma_f32 v119, v119, s48, s48
    v_rcp_f32 v116, v116
    v_rcp_f32 v117, v117
    v_rcp_f32 v118, v118
    v_rcp_f32 v119, v119
    v_mul_f32 v60, v60, v116
    ds_read_b128 a[104:107], v14 offset:5120
    v_mul_f32 v61, v61, v117
    v_mul_f32 v62, v62, v118
    v_mul_f32 v63, v63, v119
    v_cvt_pk_bf16_f32 v126, v60, v61
    v_cvt_pk_bf16_f32 v127, v62, v63
    global_store_dwordx4 v5, v[124:127], s[64:65] offset:1024 sc1
    ds_read_b128 a[108:111], v14 offset:11264
    s_mul_i32 s36, s40, 114688
    v_add_u32 v7, s36, v5
    s_sub_u32 s36, 114688, s36
    v_add_u32 v15, s36, v5
    s_lshl_b32 s36, s3, 14
    s_lshl_b32 s37, s40, 13
    s_add_u32 s36, s36, s37
    v_add_u32 v12, s36, v5
    v_xor_b32 v13, 8192, v12
    s_mul_i32 s36, s5, 224
    s_lshl_b32 s37, s3, 1
    s_add_u32 s36, s36, s37
    s_lshl_b32 s36, s36, 10
    s_add_u32 s36, s36, 8388608
    s_add_u32 s37, s6, 1
    s_add_u32 s38, s6, -6
    s_cmp_ge_u32 s37, 7
    s_cselect_b32 s37, s38, s37
    s_lshl_b32 s37, s37, 14
    s_add_u32 s37, s37, s36
    s_add_u32 s40, s30, s37
    s_addc_u32 s41, s31, 0
    s_add_u32 s37, s6, 2
    s_add_u32 s38, s6, -5
    s_cmp_ge_u32 s37, 7
    s_cselect_b32 s37, s38, s37
    s_lshl_b32 s37, s37, 14
    s_add_u32 s37, s37, s36
    s_add_u32 s42, s30, s37
    s_addc_u32 s43, s31, 0
    s_add_u32 s37, s6, 3
    s_add_u32 s38, s6, -4
    s_cmp_ge_u32 s37, 7
    s_cselect_b32 s37, s38, s37
    s_lshl_b32 s37, s37, 14
    s_add_u32 s37, s37, s36
    s_add_u32 s44, s30, s37
    s_addc_u32 s45, s31, 0
    s_add_u32 s37, s6, 4
    s_add_u32 s38, s6, -3
    s_cmp_ge_u32 s37, 7
    s_cselect_b32 s37, s38, s37
    s_lshl_b32 s37, s37, 14
    s_add_u32 s37, s37, s36
    s_add_u32 s46, s30, s37
    s_addc_u32 s47, s31, 0
    s_add_u32 s37, s6, 5
    s_add_u32 s38, s6, -2
    s_cmp_ge_u32 s37, 7
    s_cselect_b32 s37, s38, s37
    s_lshl_b32 s37, s37, 14
    s_add_u32 s37, s37, s36
    s_add_u32 s48, s30, s37
    s_addc_u32 s49, s31, 0
    s_add_u32 s37, s6, 6
    s_add_u32 s38, s6, -1
    s_cmp_ge_u32 s37, 7
    s_cselect_b32 s37, s38, s37
    s_lshl_b32 s37, s37, 14
    s_add_u32 s37, s37, s36
    s_add_u32 s50, s30, s37
    s_addc_u32 s51, s31, 0
    v_mov_b32 v8, v112
    v_mov_b32 v9, v113
    v_mov_b32 v10, v114
    v_mov_b32 v11, v115
    s_waitcnt vmcnt(0) lgkmcnt(0)
    s_barrier
    s_cmp_lg_u32 s3, 0
    s_cbranch_scc1 L_fa1
    s_mov_b64 exec, 1
    global_store_dword v2, v3, s[30:31] sc1
    s_mov_b64 exec, -1
L_fa1:
    v_mfma_f32_32x32x16_bf16 v[16:31], a[0:3], v[128:131], 0
    v_mfma_f32_32x32x16_bf16 v[32:47], a[4:7], v[128:131], 0
    v_mfma_f32_32x32x16_bf16 v[48:63], a[0:3], v[120:123], 0
    v_mfma_f32_32x32x16_bf16 v[64:79], a[4:7], v[120:123], 0
    v_mfma_f32_32x32x16_bf16 v[16:31], a[8:11], v[132:135], v[16:31]
    v_mfma_f32_32x32x16_bf16 v[32:47], a[12:15], v[132:135], v[32:47]
    v_mfma_f32_32x32x16_bf16 v[48:63], a[8:11], v[124:127], v[48:63]
    v_mfma_f32_32x32x16_bf16 v[64:79], a[12:15], v[124:127], v[64:79]
    s_cmp_lg_u32 s3, 0
    s_cbranch_scc1 L_fa2
    s_mov_b32 s60, 0
L_b3_poll:
    global_load_dword v6, v4, s[30:31] sc1
    s_waitcnt vmcnt(0)
    v_cmp_ne_u32 vcc, s7, v6
    s_cbranch_vccz L_b3_done
    s_add_u32 s60, s60, 1
    s_cmp_le_u32 s60, 20000
    s_cbranch_scc1 L_b3_poll
L_b3_done:
L_fa2:
    s_barrier
    global_load_dwordx4 v[80:83], v7, s[40:41] offset:0 sc1
    global_load_dwordx4 v[84:87], v7, s[40:41] offset:1024 sc1
    global_load_dwordx4 v[88:91], v7, s[42:43] offset:0 sc1
    global_load_dwordx4 v[92:95], v7, s[42:43] offset:1024 sc1
    global_load_dwordx4 v[96:99], v7, s[44:45] offset:0 sc1
    global_load_dwordx4 v[100:103], v7, s[44:45] offset:1024 sc1
    global_load_dwordx4 v[104:107], v7, s[46:47] offset:0 sc1
    global_load_dwordx4 v[108:111], v7, s[46:47] offset:1024 sc1
    global_load_dwordx4 v[112:115], v7, s[48:49] offset:0 sc1
    global_load_dwordx4 v[116:119], v7, s[48:49] offset:1024 sc1
    global_load_dwordx4 v[120:123], v7, s[50:51] offset:0 sc1
    global_load_dwordx4 v[124:127], v7, s[50:51] offset:1024 sc1
    global_load_dwordx4 v[128:131], v15, s[40:41] offset:0 sc1
    global_load_dwordx4 v[132:135], v15, s[40:41] offset:1024 sc1
    global_load_dwordx4 v[136:139], v15, s[42:43] offset:0 sc1
    global_load_dwordx4 v[140:143], v15, s[42:43] offset:1024 sc1
    s_waitcnt vmcnt(15)
    v_mfma_f32_32x32x16_bf16 v[16:31], a[16:19], v[80:83], v[16:31]
    v_mfma_f32_32x32x16_bf16 v[32:47], a[20:23], v[80:83], v[32:47]
    global_load_dwordx4 v[80:83], v15, s[44:45] offset:0 sc1
    s_waitcnt vmcnt(15)
    v_mfma_f32_32x32x16_bf16 v[16:31], a[24:27], v[84:87], v[16:31]
    v_mfma_f32_32x32x16_bf16 v[32:47], a[28:31], v[84:87], v[32:47]
    global_load_dwordx4 v[84:87], v15, s[44:45] offset:1024 sc1
    s_waitcnt vmcnt(15)
    v_mfma_f32_32x32x16_bf16 v[16:31], a[32:35], v[88:91], v[16:31]
    v_mfma_f32_32x32x16_bf16 v[32:47], a[36:39], v[88:91], v[32:47]
    global_load_dwordx4 v[88:91], v15, s[46:47] offset:0 sc1
    s_waitcnt vmcnt(15)
    v_mfma_f32_32x32x16_bf16 v[16:31], a[40:43], v[92:95], v[16:31]
    v_mfma_f32_32x32x16_bf16 v[32:47], a[44:47], v[92:95], v[32:47]
    global_load_dwordx4 v[92:95], v15, s[46:47] offset:1024 sc1
    s_waitcnt vmcnt(15)
    v_mfma_f32_32x32x16_bf16 v[16:31], a[48:51], v[96:99], v[16:31]
    v_mfma_f32_32x32x16_bf16 v[32:47], a[52:55], v[96:99], v[32:47]
    global_load_dwordx4 v[96:99], v15, s[48:49] offset:0 sc1
    s_waitcnt vmcnt(15)
    v_mfma_f32_32x32x16_bf16 v[16:31], a[56:59], v[100:103], v[16:31]
    v_mfma_f32_32x32x16_bf16 v[32:47], a[60:63], v[100:103], v[32:47]
    global_load_dwordx4 v[100:103], v15, s[48:49] offset:1024 sc1
    s_waitcnt vmcnt(15)
    v_mfma_f32_32x32x16_bf16 v[16:31], a[64:67], v[104:107], v[16:31]
    v_mfma_f32_32x32x16_bf16 v[32:47], a[68:71], v[104:107], v[32:47]
    global_load_dwordx4 v[104:107], v15, s[50:51] offset:0 sc1
    s_waitcnt vmcnt(15)
    v_mfma_f32_32x32x16_bf16 v[16:31], a[72:75], v[108:111], v[16:31]
    v_mfma_f32_32x32x16_bf16 v[32:47], a[76:79], v[108:111], v[32:47]
    global_load_dwordx4 v[108:111], v15, s[50:51] offset:1024 sc1
    s_waitcnt vmcnt(15)
    v_mfma_f32_32x32x16_bf16 v[16:31], a[80:83], v[112:115], v[16:31]
    v_mfma_f32_32x32x16_bf16 v[32:47], a[84:87], v[112:115], v[32:47]
    s_waitcnt vmcnt(14)
    v_mfma_f32_32x32x16_bf16 v[16:31], a[88:91], v[116:119], v[16:31]
    v_mfma_f32_32x32x16_bf16 v[32:47], a[92:95], v[116:119], v[32:47]
    s_waitcnt vmcnt(13)
    v_mfma_f32_32x32x16_bf16 v[16:31], a[96:99], v[120:123], v[16:31]
    v_mfma_f32_32x32x16_bf16 v[32:47], a[100:103], v[120:123], v[32:47]
    s_waitcnt vmcnt(12)
    v_mfma_f32_32x32x16_bf16 v[16:31], a[104:107], v[124:127], v[16:31]
    v_mfma_f32_32x32x16_bf16 v[32:47], a[108:111], v[124:127], v[32:47]
    s_waitcnt vmcnt(11)
    v_mfma_f32_32x32x16_bf16 v[48:63], a[16:19], v[128:131], v[48:63]
    v_mfma_f32_32x32x16_bf16 v[64:79], a[20:23], v[128:131], v[64:79]
    s_waitcnt vmcnt(10)
    v_mfma_f32_32x32x16_bf16 v[48:63], a[24:27], v[132:135], v[48:63]
    v_mfma_f32_32x32x16_bf16 v[64:79], a[28:31], v[132:135], v[64:79]
    s_waitcnt vmcnt(9)
    v_mfma_f32_32x32x16_bf16 v[48:63], a[32:35], v[136:139], v[48:63]
    v_mfma_f32_32x32x16_bf16 v[64:79], a[36:39], v[136:139], v[64:79]
    s_waitcnt vmcnt(8)
    v_mfma_f32_32x32x16_bf16 v[48:63], a[40:43], v[140:143], v[48:63]
    v_mfma_f32_32x32x16_bf16 v[64:79], a[44:47], v[140:143], v[64:79]
    ds_write_b128 v12, v[16:19] offset:0
    s_waitcnt vmcnt(7)
    v_mfma_f32_32x32x16_bf16 v[48:63], a[48:51], v[80:83], v[48:63]
    v_mfma_f32_32x32x16_bf16 v[64:79], a[52:55], v[80:83], v[64:79]
    ds_write_b128 v12, v[20:23] offset:1024
    s_waitcnt vmcnt(6)
    v_mfma_f32_32x32x16_bf16 v[48:63], a[56:59], v[84:87], v[48:63]
    v_mfma_f32_32x32x16_bf16 v[64:79], a[60:63], v[84:87], v[64:79]
    ds_write_b128 v12, v[24:27] offset:2048
    s_waitcnt vmcnt(5)
    v_mfma_f32_32x32x16_bf16 v[48:63], a[64:67], v[88:91], v[48:63]
    v_mfma_f32_32x32x16_bf16 v[64:79], a[68:71], v[88:91], v[64:79]
    ds_write_b128 v12, v[28:31] offset:3072
    s_waitcnt vmcnt(4)
    v_mfma_f32_32x32x16_bf16 v[48:63], a[72:75], v[92:95], v[48:63]
    v_mfma_f32_32x32x16_bf16 v[64:79], a[76:79], v[92:95], v[64:79]
    ds_write_b128 v12, v[32:35] offset:4096
    s_waitcnt vmcnt(3)
    v_mfma_f32_32x32x16_bf16 v[48:63], a[80:83], v[96:99], v[48:63]
    v_mfma_f32_32x32x16_bf16 v[64:79], a[84:87], v[96:99], v[64:79]
    ds_write_b128 v12, v[36:39] offset:5120
    s_waitcnt vmcnt(2)
    v_mfma_f32_32x32x16_bf16 v[48:63], a[88:91], v[100:103], v[48:63]
    v_mfma_f32_32x32x16_bf16 v[64:79], a[92:95], v[100:103], v[64:79]
    ds_write_b128 v12, v[40:43] offset:6144
    s_waitcnt vmcnt(1)
    v_mfma_f32_32x32x16_bf16 v[48:63], a[96:99], v[104:107], v[48:63]
    v_mfma_f32_32x32x16_bf16 v[64:79], a[100:103], v[104:107], v[64:79]
    ds_write_b128 v12, v[44:47] offset:7168
    s_waitcnt vmcnt(0)
    v_mfma_f32_32x32x16_bf16 v[48:63], a[104:107], v[108:111], v[48:63]
    v_mfma_f32_32x32x16_bf16 v[64:79], a[108:111], v[108:111], v[64:79]
    s_nop 10
    ds_write_b128 v13, v[48:51] offset:0
    ds_write_b128 v13, v[52:55] offset:1024
    ds_write_b128 v13, v[56:59] offset:2048
    ds_write_b128 v13, v[60:63] offset:3072
    ds_write_b128 v13, v[64:67] offset:4096
    ds_write_b128 v13, v[68:71] offset:5120
    ds_write_b128 v13, v[72:75] offset:6144
    ds_write_b128 v13, v[76:79] offset:7168
    s_lshl_b32 s36, s3, 11
    v_add_u32 v2, s36, v5
    v_add_u32 v3, 65536, v2
    v_and_b32 v4, 31, v1
    s_lshl_b32 s36, s5, 6
    s_lshl_b32 s37, s3, 3
    s_and_b32 s37, s37, 32
    s_add_u32 s36, s36, s37
    v_add_u32 v4, s36, v4
    v_mul_u32_u24 v4, 896, v4
    v_lshrrev_b32 v6, 5, v1
    v_lshl_add_u32 v4, v6, 4, v4
    s_lshl_b32 s36, s6, 7
    s_and_b32 s37, s3, 3
    s_lshl_b32 s37, s37, 5
    s_add_u32 s36, s36, s37
    v_add_u32 v4, s36, v4
    s_waitcnt lgkmcnt(0)
    s_barrier
    ds_read_b128 v[16:19], v2 offset:0
    ds_read_b128 v[20:23], v2 offset:1024
    ds_read_b128 v[24:27], v2 offset:16384
    ds_read_b128 v[28:31], v2 offset:17408
    ds_read_b128 v[32:35], v2 offset:32768
    ds_read_b128 v[36:39], v2 offset:33792
    ds_read_b128 v[40:43], v2 offset:49152
    ds_read_b128 v[44:47], v2 offset:50176
    ds_read_b128 v[48:51], v3 offset:0
    ds_read_b128 v[52:55], v3 offset:1024
    ds_read_b128 v[56:59], v3 offset:16384
    ds_read_b128 v[60:63], v3 offset:17408
    ds_read_b128 v[64:67], v3 offset:32768
    ds_read_b128 v[68:71], v3 offset:33792
    ds_read_b128 v[72:75], v3 offset:49152
    ds_read_b128 v[76:79], v3 offset:50176
    s_waitcnt lgkmcnt(12)
    v_pk_add_f32 v[16:17], v[16:17], v[24:25]
    v_pk_add_f32 v[18:19], v[18:19], v[26:27]
    v_pk_add_f32 v[20:21], v[20:21], v[28:29]
    v_pk_add_f32 v[22:23], v[22:23], v[30:31]
    s_waitcnt lgkmcnt(10)
    v_pk_add_f32 v[16:17], v[16:17], v[32:33]
    v_pk_add_f32 v[18:19], v[18:19], v[34:35]
    v_pk_add_f32 v[20:21], v[20:21], v[36:37]
    v_pk_add_f32 v[22:23], v[22:23], v[38:39]
    s_waitcnt lgkmcnt(8)
    v_pk_add_f32 v[16:17], v[16:17], v[40:41]
    v_pk_add_f32 v[18:19], v[18:19], v[42:43]
    v_pk_add_f32 v[20:21], v[20:21], v[44:45]
    v_pk_add_f32 v[22:23], v[22:23], v[46:47]
    s_waitcnt lgkmcnt(6)
    v_pk_add_f32 v[16:17], v[16:17], v[48:49]
    v_pk_add_f32 v[18:19], v[18:19], v[50:51]
    v_pk_add_f32 v[20:21], v[20:21], v[52:53]
    v_pk_add_f32 v[22:23], v[22:23], v[54:55]
    s_waitcnt lgkmcnt(4)
    v_pk_add_f32 v[16:17], v[16:17], v[56:57]
    v_pk_add_f32 v[18:19], v[18:19], v[58:59]
    v_pk_add_f32 v[20:21], v[20:21], v[60:61]
    v_pk_add_f32 v[22:23], v[22:23], v[62:63]
    s_waitcnt lgkmcnt(2)
    v_pk_add_f32 v[16:17], v[16:17], v[64:65]
    v_pk_add_f32 v[18:19], v[18:19], v[66:67]
    v_pk_add_f32 v[20:21], v[20:21], v[68:69]
    v_pk_add_f32 v[22:23], v[22:23], v[70:71]
    s_waitcnt lgkmcnt(0)
    v_pk_add_f32 v[16:17], v[16:17], v[72:73]
    v_pk_add_f32 v[18:19], v[18:19], v[74:75]
    v_pk_add_f32 v[20:21], v[20:21], v[76:77]
    v_pk_add_f32 v[22:23], v[22:23], v[78:79]
    v_cvt_pk_bf16_f32 v24, v16, v17
    v_cvt_pk_bf16_f32 v25, v18, v19
    v_cvt_pk_bf16_f32 v26, v20, v21
    v_cvt_pk_bf16_f32 v27, v22, v23
    v_lshlrev_b32 v16, 16, v24
    v_and_b32 v17, 0xffff0000, v24
    v_lshlrev_b32 v28, 16, v8
    v_and_b32 v29, 0xffff0000, v8
    v_lshlrev_b32 v18, 16, v25
    v_and_b32 v19, 0xffff0000, v25
    v_lshlrev_b32 v30, 16, v9
    v_and_b32 v31, 0xffff0000, v9
    v_lshlrev_b32 v20, 16, v26
    v_and_b32 v21, 0xffff0000, v26
    v_lshlrev_b32 v32, 16, v10
    v_and_b32 v33, 0xffff0000, v10
    v_lshlrev_b32 v22, 16, v27
    v_and_b32 v23, 0xffff0000, v27
    v_lshlrev_b32 v34, 16, v11
    v_and_b32 v35, 0xffff0000, v11
    v_pk_add_f32 v[16:17], v[16:17], v[28:29]
    v_pk_add_f32 v[18:19], v[18:19], v[30:31]
    v_pk_add_f32 v[20:21], v[20:21], v[32:33]
    v_pk_add_f32 v[22:23], v[22:23], v[34:35]
    v_cvt_pk_bf16_f32 v24, v16, v17
    v_cvt_pk_bf16_f32 v25, v18, v19
    v_cvt_pk_bf16_f32 v26, v20, v21
    v_cvt_pk_bf16_f32 v27, v22, v23
    s_nop 0
    v_permlane32_swap_b32 v24, v26
    v_permlane32_swap_b32 v25, v27
    global_store_dwordx4 v4, v[24:27], s[28:29]
L_end:
    s_endpgm
L_spare:
    s_waitcnt vmcnt(0)
    s_cmp_eq_u32 s3, 7
    s_cbranch_scc1 L_noxss
    global_store_dwordx4 v125, v[18:21], s[30:31] sc1
L_noxss:
    v_lshlrev_b32 v44, 16, v10
    v_and_b32 v45, 0xffff0000, v10
    v_lshlrev_b32 v46, 16, v11
    v_and_b32 v47, 0xffff0000, v11
    v_lshlrev_b32 v48, 16, v12
    v_and_b32 v49, 0xffff0000, v12
    v_lshlrev_b32 v50, 16, v13
    v_and_b32 v51, 0xffff0000, v13
    v_add_f32 v52, v44, v45
    v_mul_f32 v53, v44, v44
    v_fmac_f32 v53, v45, v45
    v_add_f32 v52, v52, v46
    v_fmac_f32 v53, v46, v46
    v_add_f32 v52, v52, v47
    v_fmac_f32 v53, v47, v47
    v_add_f32 v52, v52, v48
    v_fmac_f32 v53, v48, v48
    v_add_f32 v52, v52, v49
    v_fmac_f32 v53, v49, v49
    v_add_f32 v52, v52, v50
    v_fmac_f32 v53, v50, v50
    v_add_f32 v52, v52, v51
    v_fmac_f32 v53, v51, v51
    s_nop 0
    v_add_f32_dpp v52, v52, v52 row_ror:8 row_mask:0xf bank_mask:0xf
    v_add_f32_dpp v53, v53, v53 row_ror:8 row_mask:0xf bank_mask:0xf
    s_nop 0
    v_add_f32_dpp v52, v52, v52 row_ror:4 row_mask:0xf bank_mask:0xf
    v_add_f32_dpp v53, v53, v53 row_ror:4 row_mask:0xf bank_mask:0xf
    s_nop 0
    v_add_f32_dpp v52, v52, v52 row_ror:2 row_mask:0xf bank_mask:0xf
    v_add_f32_dpp v53, v53, v53 row_ror:2 row_mask:0xf bank_mask:0xf
    s_nop 0
    v_add_f32_dpp v52, v52, v52 row_ror:1 row_mask:0xf bank_mask:0xf
    v_add_f32_dpp v53, v53, v53 row_ror:1 row_mask:0xf bank_mask:0xf
    v_mov_b32 v54, v52
    v_mov_b32 v55, v53
    s_nop 0
    v_permlane16_swap_b32 v52, v54
    v_permlane16_swap_b32 v53, v55
    v_add_f32 v52, v52, v54
    v_add_f32 v53, v53, v55
    v_mov_b32 v54, v52
    v_mov_b32 v55, v53
    s_nop 0
    v_permlane32_swap_b32 v52, v54
    v_permlane32_swap_b32 v53, v55
    v_add_f32 v52, v52, v54
    v_add_f32 v53, v53, v55
    v_mul_f32 v52, 0x3b124925, v52
    v_mul_f32 v53, 0x3b124925, v53
    v_fma_f32 v53, -v52, v52, v53
    v_max_f32 v53, 0, v53
    v_cvt_pk_bf16_f32 v54, v52, v53
    v_lshlrev_b32 v52, 16, v54
    v_and_b32 v54, 0xffff0000, v54
    v_add_f32 v54, 0x3727c5ac, v54
    v_cvt_pk_bf16_f32 v54, v54, v54
    v_and_b32 v54, 0xffff0000, v54
    v_sqrt_f32 v54, v54
    s_nop 0
    v_cvt_pk_bf16_f32 v55, v54, v54
    v_and_b32 v55, 0xffff0000, v55
    s_waitcnt lgkmcnt(0)
    s_add_u32 s7, s7, 1
    v_and_b32 v54, 0xffff0000, v55
    v_lshrrev_b32 v52, 16, v52
    v_or_b32 v54, v54, v52
    v_mov_b32 v55, s7
    s_lshl_b32 s36, s35, 3
    s_add_u32 s36, s36, 4096
    v_mov_b32 v56, s36
    s_mov_b64 exec, 1
    global_store_dwordx2 v56, v[54:55], s[30:31] sc1
    s_mov_b64 exec, -1
    v_mov_b32 v127, s7
    global_load_lds_dwordx4 v128, s[24:25]
    s_waitcnt vmcnt(2)
    s_cmp_eq_u32 s3, 7
    s_cbranch_scc1 L_puba
    s_mov_b64 exec, 1
    global_store_dword v126, v127, s[30:31] sc1
    s_mov_b64 exec, -1
L_puba:
    s_waitcnt vmcnt(0)
    ds_read_b64_tr_b16 v[136:137], v132
    ds_read_b64_tr_b16 v[138:139], v132 offset:256
    s_waitcnt lgkmcnt(0)
    global_store_dwordx4 v130, v[136:139], s[30:31] sc1
    global_load_lds_dwordx4 v129, s[26:27]
    s_mul_i32 s36, s2, 16
    s_add_u32 s36, s36, 262144
    v_mul_u32_u24 v9, 4096, v1
    v_add_u32 v9, s36, v9
    s_waitcnt vmcnt(0)
    s_mov_b64 exec, 1
    global_store_dword v134, v127, s[30:31] sc1
    s_mov_b64 exec, -1
    ds_read_b64_tr_b16 v[136:137], v133
    ds_read_b64_tr_b16 v[138:139], v133 offset:512
    s_waitcnt lgkmcnt(0)
    global_store_dwordx4 v131, v[136:139], s[30:31] sc1
    s_waitcnt vmcnt(0)
    s_barrier
    s_mov_b64 exec, 255
    global_store_dword v9, v127, s[30:31] sc1
    s_endpgm
.section .rodata,"a"
.p2align 6
.amdhsa_kernel sequential_preLN__ssm_conv_s4d__dense_activation_silu__prompt_kernel
  .amdhsa_next_free_vgpr 256
  .amdhsa_next_free_sgpr 96
  .amdhsa_accum_offset 144
  .amdhsa_group_segment_fixed_size 0
  .amdhsa_kernarg_size 104
  .amdhsa_user_sgpr_count 2
  .amdhsa_user_sgpr_kernarg_segment_ptr 1
  .amdhsa_system_sgpr_workgroup_id_x 1
  .amdhsa_float_denorm_mode_32 3
.end_amdhsa_kernel
```
